```python
import torch

def _softmax(x, axis=-1):
    return torch.softmax(x, dim=axis)

def _gelu(x):
    return torch.nn.functional.gelu(x, approximate='tanh')

def _silu(x):
    return torch.nn.functional.silu(x)

def _sigmoid(x):
    return torch.sigmoid(x)

def _layernorm(x, axis=-1, eps=1e-05):
    m = x.mean(dim=axis, keepdim=True)
    v = x.var(dim=axis, keepdim=True, unbiased=False)
    return (x - m) / torch.sqrt(v + eps)

def _scatter_add(tgt, idx, src, axis=0):
    return tgt.clone().index_add_(axis, idx, src)

def _segment_sum(src, seg, n):
    out = torch.zeros((n,) + src.shape[1:], dtype=src.dtype)
    return out.index_add_(0, seg, src)

def _pad(x, pw):
    flat = tuple((v for pair in reversed(pw) for v in pair))
    return torch.nn.functional.pad(x, flat)
kernel_name = 'adaLN_cond__ssm_conv_h3__geglu_ffn__prompt'

def setup_inputs():

    _w = lambda a: (lambda t: t.to(torch.bfloat16) if t.is_floating_point() else t)(torch.as_tensor(a))

    def _A_setup():
        B, S, D = (1, 2048, 448)
        ks = 4
        return {'q': _w((lambda *s: torch.randn(*s, dtype=torch.bfloat16) * 0.05)(B, S, D)), 'k': _w((lambda *s: torch.randn(*s, dtype=torch.bfloat16) * 0.8)(B, S, D)), 'v': _w((lambda *s: torch.randn(*s, dtype=torch.bfloat16) * 0.8)(B, S, D)), 'shift_k': _w((lambda *s: torch.randn(*s, dtype=torch.bfloat16) * 0.8)(D, ks) * 0.5), 'ssm_k': _w((lambda *s: torch.randn(*s, dtype=torch.bfloat16) * 0.8)(D, S) * (1.0 / S ** 0.5)), 'ssm_D': _w((lambda *s: torch.randn(*s, dtype=torch.bfloat16) * 0.8)(D))}
    _A_in = _A_setup()

    def _B_setup():
        B, S, D, F = (1, 2048, 448, 1792)
        return {'x': _w((lambda *s: torch.randn(*s, dtype=torch.bfloat16) * 0.05)(B, S, D)), 'w_gate': _w((lambda *s: torch.randn(*s, dtype=torch.bfloat16) * 0.05)(D, F)), 'w_up': _w((lambda *s: torch.randn(*s, dtype=torch.bfloat16) * 0.05)(D, F)), 'w_down': _w((lambda *s: torch.randn(*s, dtype=torch.bfloat16) * 0.05)(F, D))}
    _B_in = _B_setup()
    return {'A_q': _A_in['q'], 'A_k': _A_in['k'], 'A_v': _A_in['v'], 'A_shift_k': _A_in['shift_k'], 'A_ssm_k': _A_in['ssm_k'], 'A_ssm_D': _A_in['ssm_D'], 'B_x': _B_in['x'], 'B_w_gate': _B_in['w_gate'], 'B_w_up': _B_in['w_up'], 'B_w_down': _B_in['w_down'], 'c': _w((lambda *s: torch.randn(*s, dtype=torch.bfloat16) * 0.1)(1, 448) * 8.0), 'w_mod': _w((lambda *s: torch.randn(*s, dtype=torch.bfloat16) * 0.1)(448, 6 * 448) * 448 ** (-0.5) * 8.0)}

def reference(A_q, A_k, A_v, A_shift_k, A_ssm_k, A_ssm_D, B_x, B_w_gate, B_w_up, B_w_down, c, w_mod):

    def _A_ref(q, k, v, shift_k, ssm_k, ssm_D):
        B, S, D = q.shape
        ks = shift_k.shape[-1]
        k_pad = _pad(k, ((0, 0), (ks - 1, 0), (0, 0)))
        k_shift = torch.zeros_like(k)
        for t in range(ks):
            k_shift = k_shift + k_pad[:, t:t + S, :] * shift_k[:, ks - 1 - t][None, None, :]
        kv = k_shift * v
        L = 2 * S
        kv_pad = _pad(kv, ((0, 0), (0, S), (0, 0)))
        kf_pad = _pad(ssm_k, ((0, 0), (0, S)))
        kv_f = (lambda x, axes=(-2, -1): torch.fft.rfft2(x.float(), dim=axes))(kv_pad[:, None, :, :], axes=(1, 2))
        kf_f = (lambda x, axes=(-2, -1): torch.fft.rfft2(x.float(), dim=axes))(kf_pad[:, None, :], axes=(1, 2))
        kf_f = (lambda x, *d: x.permute(*d))(kf_f, 1, 2, 0)
        y_f = kv_f * kf_f[None, :, :, :]
        y = (lambda x, s, axes=(-2, -1): torch.fft.irfft2(x, s=s, dim=axes).to(torch.bfloat16))(y_f, (1, L), axes=(1, 2))[:, 0, :S, :]
        y = y + kv * ssm_D[None, None, :]
        return q * y

    def _B_ref(x, w_gate, w_up, w_down):
        return _gelu(x @ w_gate) * (x @ w_up) @ w_down
    x = A_q
    mod = (_silu(c) @ w_mod).reshape(c.shape[0], 6, 1, -1)
    sa, ca, ga, sb, cb, gb = (mod[:, 0].clone(), mod[:, 1].clone(), mod[:, 2].clone(), mod[:, 3].clone(), mod[:, 4].clone(), mod[:, 5].clone())
    h = _layernorm(x, axis=-1) * (1 + ca) + sa
    x = x + ga * _A_ref(h, A_k, A_v, A_shift_k, A_ssm_k, A_ssm_D)
    h = _layernorm(x, axis=-1) * (1 + cb) + sb
    x = x + gb * _B_ref(h, B_w_gate, B_w_up, B_w_down)
    return x
```

```asm
; @launch kernel=adaLN_cond__ssm_conv_h3__geglu_ffn__prompt_kernel grid=(256,1,1) block=(512,1,1) lds=139328
.amdgcn_target "amdgcn-amd-amdhsa--gfx950"
.text
.globl adaLN_cond__ssm_conv_h3__geglu_ffn__prompt_kernel
.p2align 8
.type adaLN_cond__ssm_conv_h3__geglu_ffn__prompt_kernel,@function
adaLN_cond__ssm_conv_h3__geglu_ffn__prompt_kernel:
    s_cmp_ge_u32 s2, 256
    s_cbranch_scc1 M_END
    s_load_dwordx2 s[4:5], s[0:1], 112
    s_load_dwordx2 s[44:45], s[0:1], 104
    v_lshrrev_b32 v1, 6, v0
    v_mov_b32 v2, 0
    v_readfirstlane_b32 s3, v1
    v_mov_b32 v3, 139264
    ds_write_b32 v3, v2
    s_and_b32 s47, s2, 7
    s_mul_i32 s47, s47, 28
    s_lshr_b32 s46, s2, 3
    s_add_u32 s47, s47, s46
    s_lshl_b32 s47, s47, 1
    s_and_b32 s52, s2, 7
    s_lshr_b32 s53, s2, 3
    s_lshr_b32 s50, s52, 1
    s_lshl_b32 s50, s50, 2
    s_and_b32 s54, s53, 3
    s_add_u32 s50, s50, s54
    s_and_b32 s51, s52, 1
    s_mul_i32 s51, s51, 7
    s_lshr_b32 s54, s53, 2
    s_add_u32 s51, s51, s54
    s_and_b32 s63, s2, 7
    s_lshl_b32 s63, s63, 5
    s_lshr_b32 s62, s2, 3
    s_or_b32 s63, s63, s62
    s_waitcnt lgkmcnt(0)
    s_mov_b32 s20, s4
    s_and_b32 s21, s5, 0xffff
    s_mov_b32 s22, 0x1800000
    s_mov_b32 s23, 0x00020000
    s_barrier
    s_cmp_ge_u32 s2, 224
    s_cbranch_scc1 M_MODWG
    s_cmp_ge_u32 s3, 4
    s_cbranch_scc1 M_SIDE
    s_cmp_lg_u32 s3, 0
    s_cbranch_scc1 M_NORESET
    s_cmp_ge_u32 s2, 224
    s_cbranch_scc1 M_NORESET
    s_lshl_b32 s59, s2, 7
    s_add_u32 s59, s59, 0x8000
    s_mov_b64 exec, 0xff
    v_lshlrev_b32 v4, 2, v0
    buffer_store_dword v2, v4, s[20:23], s59 offen sc1
    s_mov_b64 exec, -1
M_NORESET:
    s_mov_b32 s97, 0
    s_load_dwordx2 s[6:7], s[0:1], 8
    s_load_dwordx2 s[24:25], s[0:1], 16
    s_load_dwordx2 s[26:27], s[0:1], 24
    s_mov_b32 s29, s2
    s_mov_b32 s30, 0x24924925
    s_mul_hi_u32 s31, s29, s30
    s_mul_i32 s32, s31, 7
    s_sub_u32 s32, s29, s32
    s_lshl_b32 s33, s31, 6
    v_bfe_u32 v1, v0, 4, 2
    v_lshrrev_b32 v5, 7, v0
    v_lshl_add_u32 v1, v5, 2, v1
    v_lshl_add_u32 v1, v1, 3, s33
    v_and_b32 v5, 15, v0
    v_bfe_u32 v6, v0, 6, 1
    v_lshl_add_u32 v5, v6, 4, v5
    s_lshl_b32 s34, s32, 7
    v_lshl_add_u32 v6, v5, 2, s34
    s_movk_i32 s35, 896
    v_mad_u32_u24 v2, v1, s35, v6
    v_add_u32 v3, 4480, v2
    v_subrev_u32 v4, 2688, v2
    v_lshlrev_b32 v7, 2, v6
    s_waitcnt lgkmcnt(0)
    s_mov_b32 s8, s6
    s_and_b32 s9, s7, 0xffff
    s_mov_b32 s10, 0x1c0000
    s_mov_b32 s11, 0x00020000
    s_mov_b32 s12, s24
    s_and_b32 s13, s25, 0xffff
    s_mov_b32 s14, 0x1c0000
    s_mov_b32 s15, 0x00020000
    s_mov_b32 s16, s26
    s_and_b32 s17, s27, 0xffff
    s_mov_b32 s18, 0xe00
    s_mov_b32 s19, 0x00020000
    buffer_load_dwordx4 v[32:35], v7, s[16:19], 0 offen
    buffer_load_dword v10, v4, s[8:11], 0 offen offset:0
    buffer_load_dword v11, v4, s[8:11], 0 offen offset:896
    buffer_load_dword v12, v4, s[8:11], 0 offen offset:1792
    buffer_load_dword v13, v2, s[8:11], 0 offen offset:0
    buffer_load_dword v14, v2, s[8:11], 0 offen offset:896
    buffer_load_dword v15, v2, s[8:11], 0 offen offset:1792
    buffer_load_dword v16, v2, s[8:11], 0 offen offset:2688
    buffer_load_dword v17, v2, s[8:11], 0 offen offset:3584
    buffer_load_dword v18, v3, s[8:11], 0 offen offset:0
    buffer_load_dword v19, v3, s[8:11], 0 offen offset:896
    buffer_load_dword v20, v3, s[8:11], 0 offen offset:1792
    buffer_load_dword v22, v2, s[12:15], 0 offen offset:0
    buffer_load_dword v23, v2, s[12:15], 0 offen offset:896
    buffer_load_dword v24, v2, s[12:15], 0 offen offset:1792
    buffer_load_dword v25, v2, s[12:15], 0 offen offset:2688
    buffer_load_dword v26, v2, s[12:15], 0 offen offset:3584
    buffer_load_dword v27, v3, s[12:15], 0 offen offset:0
    buffer_load_dword v28, v3, s[12:15], 0 offen offset:896
    buffer_load_dword v29, v3, s[12:15], 0 offen offset:1792
    v_lshrrev_b32 v8, 5, v1
    v_lshlrev_b32 v8, 6, v8
    v_bfe_u32 v9, v1, 3, 2
    v_sub_u32 v9, 3, v9
    v_lshl_add_u32 v8, v9, 4, v8
    v_lshl_add_u32 v8, v6, 11, v8
    v_add_u32 v8, 0x10000, v8
    s_waitcnt vmcnt(19)
    v_lshlrev_b32 v78, 16, v32
    v_lshlrev_b32 v79, 16, v34
    v_and_b32 v80, 0xffff0000, v32
    v_and_b32 v81, 0xffff0000, v34
    v_lshlrev_b32 v82, 16, v33
    v_lshlrev_b32 v83, 16, v35
    v_and_b32 v84, 0xffff0000, v33
    v_and_b32 v85, 0xffff0000, v35
    s_waitcnt vmcnt(8)
    v_lshlrev_b32 v40, 16, v10
    v_and_b32 v41, 0xffff0000, v10
    v_lshlrev_b32 v42, 16, v11
    v_and_b32 v43, 0xffff0000, v11
    v_lshlrev_b32 v44, 16, v12
    v_and_b32 v45, 0xffff0000, v12
    v_lshlrev_b32 v46, 16, v13
    v_and_b32 v47, 0xffff0000, v13
    v_lshlrev_b32 v48, 16, v14
    v_and_b32 v49, 0xffff0000, v14
    v_lshlrev_b32 v50, 16, v15
    v_and_b32 v51, 0xffff0000, v15
    v_lshlrev_b32 v52, 16, v16
    v_and_b32 v53, 0xffff0000, v16
    v_lshlrev_b32 v54, 16, v17
    v_and_b32 v55, 0xffff0000, v17
    v_lshlrev_b32 v56, 16, v18
    v_and_b32 v57, 0xffff0000, v18
    v_lshlrev_b32 v58, 16, v19
    v_and_b32 v59, 0xffff0000, v19
    v_lshlrev_b32 v60, 16, v20
    v_and_b32 v61, 0xffff0000, v20
    v_pk_mul_f32 v[116:117], v[40:41], v[84:85]
    v_pk_mul_f32 v[122:123], v[42:43], v[84:85]
    v_pk_mul_f32 v[128:129], v[44:45], v[84:85]
    v_pk_mul_f32 v[134:135], v[46:47], v[84:85]
    v_cvt_pk_bf16_f32 v120, v116, v117
    v_lshlrev_b32 v116, 16, v120
    v_and_b32 v117, 0xffff0000, v120
    v_cvt_pk_bf16_f32 v126, v122, v123
    v_lshlrev_b32 v122, 16, v126
    v_and_b32 v123, 0xffff0000, v126
    v_cvt_pk_bf16_f32 v132, v128, v129
    v_lshlrev_b32 v128, 16, v132
    v_and_b32 v129, 0xffff0000, v132
    v_cvt_pk_bf16_f32 v138, v134, v135
    v_lshlrev_b32 v134, 16, v138
    v_and_b32 v135, 0xffff0000, v138
    v_pk_mul_f32 v[118:119], v[42:43], v[82:83]
    v_pk_mul_f32 v[124:125], v[44:45], v[82:83]
    v_pk_mul_f32 v[130:131], v[46:47], v[82:83]
    v_pk_mul_f32 v[136:137], v[48:49], v[82:83]
    v_cvt_pk_bf16_f32 v120, v118, v119
    v_lshlrev_b32 v118, 16, v120
    v_and_b32 v119, 0xffff0000, v120
    v_cvt_pk_bf16_f32 v126, v124, v125
    v_lshlrev_b32 v124, 16, v126
    v_and_b32 v125, 0xffff0000, v126
    v_cvt_pk_bf16_f32 v132, v130, v131
    v_lshlrev_b32 v130, 16, v132
    v_and_b32 v131, 0xffff0000, v132
    v_cvt_pk_bf16_f32 v138, v136, v137
    v_lshlrev_b32 v136, 16, v138
    v_and_b32 v137, 0xffff0000, v138
    v_pk_add_f32 v[116:117], v[116:117], v[118:119]
    v_pk_add_f32 v[122:123], v[122:123], v[124:125]
    v_pk_add_f32 v[128:129], v[128:129], v[130:131]
    v_pk_add_f32 v[134:135], v[134:135], v[136:137]
    v_cvt_pk_bf16_f32 v120, v116, v117
    v_lshlrev_b32 v116, 16, v120
    v_and_b32 v117, 0xffff0000, v120
    v_cvt_pk_bf16_f32 v126, v122, v123
    v_lshlrev_b32 v122, 16, v126
    v_and_b32 v123, 0xffff0000, v126
    v_cvt_pk_bf16_f32 v132, v128, v129
    v_lshlrev_b32 v128, 16, v132
    v_and_b32 v129, 0xffff0000, v132
    v_cvt_pk_bf16_f32 v138, v134, v135
    v_lshlrev_b32 v134, 16, v138
    v_and_b32 v135, 0xffff0000, v138
    v_pk_mul_f32 v[118:119], v[44:45], v[80:81]
    v_pk_mul_f32 v[124:125], v[46:47], v[80:81]
    v_pk_mul_f32 v[130:131], v[48:49], v[80:81]
    v_pk_mul_f32 v[136:137], v[50:51], v[80:81]
    v_cvt_pk_bf16_f32 v120, v118, v119
    v_lshlrev_b32 v118, 16, v120
    v_and_b32 v119, 0xffff0000, v120
    v_cvt_pk_bf16_f32 v126, v124, v125
    v_lshlrev_b32 v124, 16, v126
    v_and_b32 v125, 0xffff0000, v126
    v_cvt_pk_bf16_f32 v132, v130, v131
    v_lshlrev_b32 v130, 16, v132
    v_and_b32 v131, 0xffff0000, v132
    v_cvt_pk_bf16_f32 v138, v136, v137
    v_lshlrev_b32 v136, 16, v138
    v_and_b32 v137, 0xffff0000, v138
    v_pk_add_f32 v[116:117], v[116:117], v[118:119]
    v_pk_add_f32 v[122:123], v[122:123], v[124:125]
    v_pk_add_f32 v[128:129], v[128:129], v[130:131]
    v_pk_add_f32 v[134:135], v[134:135], v[136:137]
    v_cvt_pk_bf16_f32 v120, v116, v117
    v_lshlrev_b32 v116, 16, v120
    v_and_b32 v117, 0xffff0000, v120
    v_cvt_pk_bf16_f32 v126, v122, v123
    v_lshlrev_b32 v122, 16, v126
    v_and_b32 v123, 0xffff0000, v126
    v_cvt_pk_bf16_f32 v132, v128, v129
    v_lshlrev_b32 v128, 16, v132
    v_and_b32 v129, 0xffff0000, v132
    v_cvt_pk_bf16_f32 v138, v134, v135
    v_lshlrev_b32 v134, 16, v138
    v_and_b32 v135, 0xffff0000, v138
    v_pk_mul_f32 v[118:119], v[46:47], v[78:79]
    v_pk_mul_f32 v[124:125], v[48:49], v[78:79]
    v_pk_mul_f32 v[130:131], v[50:51], v[78:79]
    v_pk_mul_f32 v[136:137], v[52:53], v[78:79]
    v_cvt_pk_bf16_f32 v120, v118, v119
    v_lshlrev_b32 v118, 16, v120
    v_and_b32 v119, 0xffff0000, v120
    v_cvt_pk_bf16_f32 v126, v124, v125
    v_lshlrev_b32 v124, 16, v126
    v_and_b32 v125, 0xffff0000, v126
    v_cvt_pk_bf16_f32 v132, v130, v131
    v_lshlrev_b32 v130, 16, v132
    v_and_b32 v131, 0xffff0000, v132
    v_cvt_pk_bf16_f32 v138, v136, v137
    v_lshlrev_b32 v136, 16, v138
    v_and_b32 v137, 0xffff0000, v138
    v_pk_add_f32 v[116:117], v[116:117], v[118:119]
    v_pk_add_f32 v[122:123], v[122:123], v[124:125]
    v_pk_add_f32 v[128:129], v[128:129], v[130:131]
    v_pk_add_f32 v[134:135], v[134:135], v[136:137]
    v_cvt_pk_bf16_f32 v120, v116, v117
    v_lshlrev_b32 v116, 16, v120
    v_and_b32 v117, 0xffff0000, v120
    v_cvt_pk_bf16_f32 v126, v122, v123
    v_lshlrev_b32 v122, 16, v126
    v_and_b32 v123, 0xffff0000, v126
    v_cvt_pk_bf16_f32 v132, v128, v129
    v_lshlrev_b32 v128, 16, v132
    v_and_b32 v129, 0xffff0000, v132
    v_cvt_pk_bf16_f32 v138, v134, v135
    v_lshlrev_b32 v134, 16, v138
    v_and_b32 v135, 0xffff0000, v138
    s_waitcnt vmcnt(0)
    v_lshlrev_b32 v62, 16, v22
    v_and_b32 v63, 0xffff0000, v22
    v_lshlrev_b32 v64, 16, v23
    v_and_b32 v65, 0xffff0000, v23
    v_lshlrev_b32 v66, 16, v24
    v_and_b32 v67, 0xffff0000, v24
    v_lshlrev_b32 v68, 16, v25
    v_and_b32 v69, 0xffff0000, v25
    v_lshlrev_b32 v70, 16, v26
    v_and_b32 v71, 0xffff0000, v26
    v_lshlrev_b32 v72, 16, v27
    v_and_b32 v73, 0xffff0000, v27
    v_lshlrev_b32 v74, 16, v28
    v_and_b32 v75, 0xffff0000, v28
    v_lshlrev_b32 v76, 16, v29
    v_and_b32 v77, 0xffff0000, v29
    v_pk_mul_f32 v[92:93], v[116:117], v[62:63]
    v_pk_mul_f32 v[94:95], v[122:123], v[64:65]
    v_pk_mul_f32 v[96:97], v[128:129], v[66:67]
    v_pk_mul_f32 v[98:99], v[134:135], v[68:69]
    v_pk_mul_f32 v[116:117], v[48:49], v[84:85]
    v_pk_mul_f32 v[122:123], v[50:51], v[84:85]
    v_pk_mul_f32 v[128:129], v[52:53], v[84:85]
    v_pk_mul_f32 v[134:135], v[54:55], v[84:85]
    v_cvt_pk_bf16_f32 v120, v116, v117
    v_lshlrev_b32 v116, 16, v120
    v_and_b32 v117, 0xffff0000, v120
    v_cvt_pk_bf16_f32 v126, v122, v123
    v_lshlrev_b32 v122, 16, v126
    v_and_b32 v123, 0xffff0000, v126
    v_cvt_pk_bf16_f32 v132, v128, v129
    v_lshlrev_b32 v128, 16, v132
    v_and_b32 v129, 0xffff0000, v132
    v_cvt_pk_bf16_f32 v138, v134, v135
    v_lshlrev_b32 v134, 16, v138
    v_and_b32 v135, 0xffff0000, v138
    v_pk_mul_f32 v[118:119], v[50:51], v[82:83]
    v_pk_mul_f32 v[124:125], v[52:53], v[82:83]
    v_pk_mul_f32 v[130:131], v[54:55], v[82:83]
    v_pk_mul_f32 v[136:137], v[56:57], v[82:83]
    v_cvt_pk_bf16_f32 v120, v118, v119
    v_lshlrev_b32 v118, 16, v120
    v_and_b32 v119, 0xffff0000, v120
    v_cvt_pk_bf16_f32 v126, v124, v125
    v_lshlrev_b32 v124, 16, v126
    v_and_b32 v125, 0xffff0000, v126
    v_cvt_pk_bf16_f32 v132, v130, v131
    v_lshlrev_b32 v130, 16, v132
    v_and_b32 v131, 0xffff0000, v132
    v_cvt_pk_bf16_f32 v138, v136, v137
    v_lshlrev_b32 v136, 16, v138
    v_and_b32 v137, 0xffff0000, v138
    v_pk_add_f32 v[116:117], v[116:117], v[118:119]
    v_pk_add_f32 v[122:123], v[122:123], v[124:125]
    v_pk_add_f32 v[128:129], v[128:129], v[130:131]
    v_pk_add_f32 v[134:135], v[134:135], v[136:137]
    v_cvt_pk_bf16_f32 v120, v116, v117
    v_lshlrev_b32 v116, 16, v120
    v_and_b32 v117, 0xffff0000, v120
    v_cvt_pk_bf16_f32 v126, v122, v123
    v_lshlrev_b32 v122, 16, v126
    v_and_b32 v123, 0xffff0000, v126
    v_cvt_pk_bf16_f32 v132, v128, v129
    v_lshlrev_b32 v128, 16, v132
    v_and_b32 v129, 0xffff0000, v132
    v_cvt_pk_bf16_f32 v138, v134, v135
    v_lshlrev_b32 v134, 16, v138
    v_and_b32 v135, 0xffff0000, v138
    v_pk_mul_f32 v[118:119], v[52:53], v[80:81]
    v_pk_mul_f32 v[124:125], v[54:55], v[80:81]
    v_pk_mul_f32 v[130:131], v[56:57], v[80:81]
    v_pk_mul_f32 v[136:137], v[58:59], v[80:81]
    v_cvt_pk_bf16_f32 v120, v118, v119
    v_lshlrev_b32 v118, 16, v120
    v_and_b32 v119, 0xffff0000, v120
    v_cvt_pk_bf16_f32 v126, v124, v125
    v_lshlrev_b32 v124, 16, v126
    v_and_b32 v125, 0xffff0000, v126
    v_cvt_pk_bf16_f32 v132, v130, v131
    v_lshlrev_b32 v130, 16, v132
    v_and_b32 v131, 0xffff0000, v132
    v_cvt_pk_bf16_f32 v138, v136, v137
    v_lshlrev_b32 v136, 16, v138
    v_and_b32 v137, 0xffff0000, v138
    v_pk_add_f32 v[116:117], v[116:117], v[118:119]
    v_pk_add_f32 v[122:123], v[122:123], v[124:125]
    v_pk_add_f32 v[128:129], v[128:129], v[130:131]
    v_pk_add_f32 v[134:135], v[134:135], v[136:137]
    v_cvt_pk_bf16_f32 v120, v116, v117
    v_lshlrev_b32 v116, 16, v120
    v_and_b32 v117, 0xffff0000, v120
    v_cvt_pk_bf16_f32 v126, v122, v123
    v_lshlrev_b32 v122, 16, v126
    v_and_b32 v123, 0xffff0000, v126
    v_cvt_pk_bf16_f32 v132, v128, v129
    v_lshlrev_b32 v128, 16, v132
    v_and_b32 v129, 0xffff0000, v132
    v_cvt_pk_bf16_f32 v138, v134, v135
    v_lshlrev_b32 v134, 16, v138
    v_and_b32 v135, 0xffff0000, v138
    v_pk_mul_f32 v[118:119], v[54:55], v[78:79]
    v_pk_mul_f32 v[124:125], v[56:57], v[78:79]
    v_pk_mul_f32 v[130:131], v[58:59], v[78:79]
    v_pk_mul_f32 v[136:137], v[60:61], v[78:79]
    v_cvt_pk_bf16_f32 v120, v118, v119
    v_lshlrev_b32 v118, 16, v120
    v_and_b32 v119, 0xffff0000, v120
    v_cvt_pk_bf16_f32 v126, v124, v125
    v_lshlrev_b32 v124, 16, v126
    v_and_b32 v125, 0xffff0000, v126
    v_cvt_pk_bf16_f32 v132, v130, v131
    v_lshlrev_b32 v130, 16, v132
    v_and_b32 v131, 0xffff0000, v132
    v_cvt_pk_bf16_f32 v138, v136, v137
    v_lshlrev_b32 v136, 16, v138
    v_and_b32 v137, 0xffff0000, v138
    v_pk_add_f32 v[116:117], v[116:117], v[118:119]
    v_pk_add_f32 v[122:123], v[122:123], v[124:125]
    v_pk_add_f32 v[128:129], v[128:129], v[130:131]
    v_pk_add_f32 v[134:135], v[134:135], v[136:137]
    v_cvt_pk_bf16_f32 v120, v116, v117
    v_lshlrev_b32 v116, 16, v120
    v_and_b32 v117, 0xffff0000, v120
    v_cvt_pk_bf16_f32 v126, v122, v123
    v_lshlrev_b32 v122, 16, v126
    v_and_b32 v123, 0xffff0000, v126
    v_cvt_pk_bf16_f32 v132, v128, v129
    v_lshlrev_b32 v128, 16, v132
    v_and_b32 v129, 0xffff0000, v132
    v_cvt_pk_bf16_f32 v138, v134, v135
    v_lshlrev_b32 v134, 16, v138
    v_and_b32 v135, 0xffff0000, v138
    v_pk_mul_f32 v[100:101], v[116:117], v[70:71]
    v_pk_mul_f32 v[102:103], v[122:123], v[72:73]
    v_pk_mul_f32 v[104:105], v[128:129], v[74:75]
    v_pk_mul_f32 v[106:107], v[134:135], v[76:77]
    v_cvt_pk_bf16_f32 v108, v106, v104
    v_cvt_pk_bf16_f32 v109, v102, v100
    v_cvt_pk_bf16_f32 v110, v98, v96
    v_cvt_pk_bf16_f32 v111, v94, v92
    v_cvt_pk_bf16_f32 v112, v107, v105
    v_cvt_pk_bf16_f32 v113, v103, v101
    v_cvt_pk_bf16_f32 v114, v99, v97
    v_cvt_pk_bf16_f32 v115, v95, v93
    buffer_store_dwordx4 v[108:111], v8, s[20:23], 0 offen sc1
    v_add_u32 v9, 4096, v8
    buffer_store_dwordx4 v[112:115], v9, s[20:23], 0 offen sc1
    s_waitcnt vmcnt(0)
    v_mov_b32 v3, 139264
    v_mov_b32 v2, 1
    s_mov_b64 exec, 1
    ds_add_rtn_u32 v2, v3, v2
    s_waitcnt lgkmcnt(0)
    v_cmp_eq_u32 vcc, 3, v2
    s_mov_b64 exec, -1
    s_cbranch_vccz M_P0DONE
M_ARR0:
    s_mov_b32 s72, s44
    s_and_b32 s73, s45, 0xffff
    s_mov_b32 s74, 0x100
    s_mov_b32 s75, 0x00020000
    s_and_b32 s59, s2, 1
    s_lshl_b32 s59, s59, 6
    v_mov_b32 v1, 0
    v_mov_b32 v2, 1
    s_mov_b64 exec, 1
    buffer_atomic_add v2, v1, s[72:75], s59 offen sc0 sc1
    s_waitcnt vmcnt(0)
    v_cmp_eq_u32 vcc, 127, v2
    s_cbranch_vccz M_A0X
    s_mov_b64 exec, 3
    v_and_b32 v1, 63, v0
    v_lshlrev_b32 v1, 6, v1
    v_mov_b32 v2, 1
    s_lshr_b32 s59, s59, 4
    s_add_u32 s59, s59, 128
    buffer_store_dword v2, v1, s[72:75], s59 offen sc1
M_A0X:
    s_mov_b64 exec, -1
    s_cmp_ge_u32 s2, 224
    s_cbranch_scc1 M_MOD2
    s_branch M_P0DONE
M_SIDE:
    s_load_dwordx2 s[6:7], s[0:1], 32
    v_and_b32 v1, 255, v0
    v_lshlrev_b32 v2, 4, v1
    v_subrev_u32 v3, 64, v2
    v_subrev_u32 v8, 48, v2
    v_add_u32 v9, 4032, v2
    s_waitcnt lgkmcnt(0)
    s_lshl_b32 s32, s47, 12
    s_add_u32 s6, s6, s32
    s_addc_u32 s7, s7, 0
    s_mov_b32 s8, s6
    s_and_b32 s9, s7, 0xffff
    s_mov_b32 s10, 0x1000
    s_mov_b32 s11, 0x00020000
    s_add_u32 s6, s6, 4096
    s_addc_u32 s7, s7, 0
    s_mov_b32 s12, s6
    s_and_b32 s13, s7, 0xffff
    s_mov_b32 s14, 0x1000
    s_mov_b32 s15, 0x00020000
    buffer_load_dwordx4 v[16:19], v3, s[8:11], 0 offen
    buffer_load_dwordx4 v[20:23], v8, s[8:11], 0 offen
    buffer_load_dwordx4 v[24:27], v3, s[12:15], 0 offen
    buffer_load_dwordx4 v[28:31], v8, s[12:15], 0 offen
    buffer_load_dwordx4 v[96:99], v9, s[8:11], 0 offen
    buffer_load_dwordx4 v[100:103], v9, s[8:11], 0 offen offset:16
    buffer_load_dwordx4 v[104:107], v9, s[12:15], 0 offen
    buffer_load_dwordx4 v[108:111], v9, s[12:15], 0 offen offset:16
    v_mov_b32 v12, 0
    v_mov_b32 v13, 0
    v_mov_b32 v14, 0
    v_mov_b32 v15, 0
    v_add_u32 v4, 43008, v2
    v_cmp_gt_u32 vcc, 160, v1
    s_and_saveexec_b64 s[36:37], vcc
    ds_write_b128 v2, v[12:15] offset:35328
    ds_write_b128 v4, v[12:15] offset:35328
    s_mov_b64 exec, s[36:37]
    s_waitcnt vmcnt(0)
    v_alignbyte_b32 v40, v17, v16, 2
    v_alignbyte_b32 v41, v18, v17, 2
    v_alignbyte_b32 v42, v19, v18, 2
    v_alignbyte_b32 v43, v20, v19, 2
    v_alignbyte_b32 v44, v21, v20, 2
    v_alignbyte_b32 v45, v22, v21, 2
    v_alignbyte_b32 v46, v23, v22, 2
    v_mov_b32 v50, v41
    v_mov_b32 v51, v42
    v_mov_b32 v52, v43
    v_mov_b32 v53, v44
    v_mov_b32 v54, v45
    v_mov_b32 v55, v46
    v_mov_b32 v58, v17
    v_mov_b32 v59, v18
    v_mov_b32 v60, v19
    v_mov_b32 v61, v20
    v_mov_b32 v62, v21
    v_mov_b32 v63, v22
    ds_write_b128 v2, v[40:43] offset:0
    ds_write_b128 v2, v[58:61] offset:4416
    ds_write_b128 v2, v[50:53] offset:8832
    ds_write_b128 v2, v[18:21] offset:13248
    ds_write_b128 v2, v[42:45] offset:17664
    ds_write_b128 v2, v[60:63] offset:22080
    ds_write_b128 v2, v[52:55] offset:26496
    ds_write_b128 v2, v[20:23] offset:30912
    v_alignbyte_b32 v40, v25, v24, 2
    v_alignbyte_b32 v41, v26, v25, 2
    v_alignbyte_b32 v42, v27, v26, 2
    v_alignbyte_b32 v43, v28, v27, 2
    v_alignbyte_b32 v44, v29, v28, 2
    v_alignbyte_b32 v45, v30, v29, 2
    v_alignbyte_b32 v46, v31, v30, 2
    v_mov_b32 v50, v41
    v_mov_b32 v51, v42
    v_mov_b32 v52, v43
    v_mov_b32 v53, v44
    v_mov_b32 v54, v45
    v_mov_b32 v55, v46
    v_mov_b32 v58, v25
    v_mov_b32 v59, v26
    v_mov_b32 v60, v27
    v_mov_b32 v61, v28
    v_mov_b32 v62, v29
    v_mov_b32 v63, v30
    ds_write_b128 v4, v[40:43] offset:0
    ds_write_b128 v4, v[58:61] offset:4416
    ds_write_b128 v4, v[50:53] offset:8832
    ds_write_b128 v4, v[26:29] offset:13248
    ds_write_b128 v4, v[42:45] offset:17664
    ds_write_b128 v4, v[60:63] offset:22080
    ds_write_b128 v4, v[52:55] offset:26496
    ds_write_b128 v4, v[28:31] offset:30912
    v_cmp_gt_u32 vcc, 3, v1
    s_and_saveexec_b64 s[36:37], vcc
    s_cbranch_execz BLD_1
    v_add_u32 v3, 4096, v2
    v_add_u32 v5, 4096, v4
    v_alignbyte_b32 v40, v97, v96, 2
    v_alignbyte_b32 v41, v98, v97, 2
    v_alignbyte_b32 v42, v99, v98, 2
    v_alignbyte_b32 v43, v100, v99, 2
    v_alignbyte_b32 v44, v101, v100, 2
    v_alignbyte_b32 v45, v102, v101, 2
    v_alignbyte_b32 v46, v103, v102, 2
    v_mov_b32 v50, v41
    v_mov_b32 v51, v42
    v_mov_b32 v52, v43
    v_mov_b32 v53, v44
    v_mov_b32 v54, v45
    v_mov_b32 v55, v46
    v_mov_b32 v58, v97
    v_mov_b32 v59, v98
    v_mov_b32 v60, v99
    v_mov_b32 v61, v100
    v_mov_b32 v62, v101
    v_mov_b32 v63, v102
    ds_write_b128 v3, v[40:43] offset:0
    ds_write_b128 v3, v[58:61] offset:4416
    ds_write_b128 v3, v[50:53] offset:8832
    ds_write_b128 v3, v[98:101] offset:13248
    ds_write_b128 v3, v[42:45] offset:17664
    ds_write_b128 v3, v[60:63] offset:22080
    ds_write_b128 v3, v[52:55] offset:26496
    ds_write_b128 v3, v[100:103] offset:30912
    v_alignbyte_b32 v40, v105, v104, 2
    v_alignbyte_b32 v41, v106, v105, 2
    v_alignbyte_b32 v42, v107, v106, 2
    v_alignbyte_b32 v43, v108, v107, 2
    v_alignbyte_b32 v44, v109, v108, 2
    v_alignbyte_b32 v45, v110, v109, 2
    v_alignbyte_b32 v46, v111, v110, 2
    v_mov_b32 v50, v41
    v_mov_b32 v51, v42
    v_mov_b32 v52, v43
    v_mov_b32 v53, v44
    v_mov_b32 v54, v45
    v_mov_b32 v55, v46
    v_mov_b32 v58, v105
    v_mov_b32 v59, v106
    v_mov_b32 v60, v107
    v_mov_b32 v61, v108
    v_mov_b32 v62, v109
    v_mov_b32 v63, v110
    ds_write_b128 v5, v[40:43] offset:0
    ds_write_b128 v5, v[58:61] offset:4416
    ds_write_b128 v5, v[50:53] offset:8832
    ds_write_b128 v5, v[106:109] offset:13248
    ds_write_b128 v5, v[42:45] offset:17664
    ds_write_b128 v5, v[60:63] offset:22080
    ds_write_b128 v5, v[52:55] offset:26496
    ds_write_b128 v5, v[108:111] offset:30912
BLD_1:
    s_mov_b64 exec, s[36:37]
    s_branch M_P0DONE
M_MODWG:
    s_cmp_eq_u32 s3, 7
    s_cbranch_scc1 M_ARR0
M_MOD2:
    s_cmp_lg_u32 s3, 6
    s_cbranch_scc1 M_NOPF
    s_getpc_b64 s[36:37]
M_PCREF:
    s_sub_u32 s36, s36, M_PCREF-adaLN_cond__ssm_conv_h3__geglu_ffn__prompt_kernel
    s_subb_u32 s37, s37, 0
    v_and_b32 v4, 63, v0
    v_lshlrev_b32 v4, 6, v4
    s_mov_b32 s38, (M_CODE_END-adaLN_cond__ssm_conv_h3__geglu_ffn__prompt_kernel)/4096
M_PFL:
    global_load_dword v5, v4, s[36:37]
    s_add_u32 s36, s36, 4096
    s_addc_u32 s37, s37, 0
    s_sub_u32 s38, s38, 1
    s_cmp_lg_u32 s38, 0
    s_cbranch_scc1 M_PFL
M_NOPF:
    s_load_dwordx2 s[6:7], s[0:1], 80
    s_load_dwordx2 s[24:25], s[0:1], 88
    s_mov_b32 s97, 0
    s_waitcnt lgkmcnt(0)
    s_mov_b32 s8, s6
    s_and_b32 s9, s7, 0xffff
    s_mov_b32 s10, 0x380
    s_mov_b32 s11, 0x00020000
    s_mov_b32 s12, s24
    s_and_b32 s13, s25, 0xffff
    s_mov_b32 s14, 0x24c000
    s_mov_b32 s15, 0x00020000
    s_sub_u32 s30, s2, 224
    s_cmp_ge_u32 s30, 28
    s_cbranch_scc1 MOD_2END
    s_mul_i32 s31, s30, 192
    s_cmp_ge_u32 s3, 6
    s_cbranch_scc1 MOD_2IDLE
    s_mov_b32 s32, 0x15555556
    v_mul_hi_u32 v2, v0, s32
    v_mul_u32_u24 v1, 12, v2
    v_sub_u32 v1, v0, v1
    s_mov_b32 s32, 75264
    v_mul_lo_u32 v3, v2, s32
    v_lshl_add_u32 v3, v1, 4, v3
    v_add_u32 v3, s31, v3
    v_mul_u32_u24 v4, 28, v2
    buffer_load_dword v10, v4, s[8:11], 0 offen offset:0
    buffer_load_dword v11, v4, s[8:11], 0 offen offset:4
    buffer_load_dword v12, v4, s[8:11], 0 offen offset:8
    buffer_load_dword v13, v4, s[8:11], 0 offen offset:12
    buffer_load_dword v14, v4, s[8:11], 0 offen offset:16
    buffer_load_dword v15, v4, s[8:11], 0 offen offset:20
    buffer_load_dword v16, v4, s[8:11], 0 offen offset:24
    s_mov_b32 s33, 0
    buffer_load_dwordx4 v[20:23], v3, s[12:15], s33 offen
    s_add_u32 s33, s33, 5376
    buffer_load_dwordx4 v[24:27], v3, s[12:15], s33 offen
    s_add_u32 s33, s33, 5376
    buffer_load_dwordx4 v[28:31], v3, s[12:15], s33 offen
    s_add_u32 s33, s33, 5376
    buffer_load_dwordx4 v[32:35], v3, s[12:15], s33 offen
    s_add_u32 s33, s33, 5376
    buffer_load_dwordx4 v[36:39], v3, s[12:15], s33 offen
    s_add_u32 s33, s33, 5376
    buffer_load_dwordx4 v[40:43], v3, s[12:15], s33 offen
    s_add_u32 s33, s33, 5376
    buffer_load_dwordx4 v[44:47], v3, s[12:15], s33 offen
    s_add_u32 s33, s33, 5376
    buffer_load_dwordx4 v[48:51], v3, s[12:15], s33 offen
    s_add_u32 s33, s33, 5376
    buffer_load_dwordx4 v[52:55], v3, s[12:15], s33 offen
    s_add_u32 s33, s33, 5376
    buffer_load_dwordx4 v[56:59], v3, s[12:15], s33 offen
    s_add_u32 s33, s33, 5376
    buffer_load_dwordx4 v[60:63], v3, s[12:15], s33 offen
    s_add_u32 s33, s33, 5376
    buffer_load_dwordx4 v[64:67], v3, s[12:15], s33 offen
    s_add_u32 s33, s33, 5376
    buffer_load_dwordx4 v[68:71], v3, s[12:15], s33 offen
    s_add_u32 s33, s33, 5376
    buffer_load_dwordx4 v[72:75], v3, s[12:15], s33 offen
    s_add_u32 s33, s33, 5376
    s_waitcnt vmcnt(14)
    v_lshlrev_b32 v80, 16, v10
    v_and_b32 v81, 0xffff0000, v10
    v_lshlrev_b32 v82, 16, v11
    v_and_b32 v83, 0xffff0000, v11
    v_lshlrev_b32 v84, 16, v12
    v_and_b32 v85, 0xffff0000, v12
    v_lshlrev_b32 v86, 16, v13
    v_and_b32 v87, 0xffff0000, v13
    v_lshlrev_b32 v88, 16, v14
    v_and_b32 v89, 0xffff0000, v14
    v_lshlrev_b32 v90, 16, v15
    v_and_b32 v91, 0xffff0000, v15
    v_lshlrev_b32 v92, 16, v16
    v_and_b32 v93, 0xffff0000, v16
    s_mov_b32 s34, 0xbfb8aa3b
    v_mul_f32 v96, s34, v80
    v_mul_f32 v97, s34, v81
    v_mul_f32 v98, s34, v82
    v_mul_f32 v99, s34, v83
    v_mul_f32 v100, s34, v84
    v_mul_f32 v101, s34, v85
    v_mul_f32 v102, s34, v86
    v_mul_f32 v103, s34, v87
    v_mul_f32 v104, s34, v88
    v_mul_f32 v105, s34, v89
    v_mul_f32 v106, s34, v90
    v_mul_f32 v107, s34, v91
    v_mul_f32 v108, s34, v92
    v_mul_f32 v109, s34, v93
    v_exp_f32 v96, v96
    v_exp_f32 v97, v97
    v_exp_f32 v98, v98
    v_exp_f32 v99, v99
    v_exp_f32 v100, v100
    v_exp_f32 v101, v101
    v_exp_f32 v102, v102
    v_exp_f32 v103, v103
    v_exp_f32 v104, v104
    v_exp_f32 v105, v105
    v_exp_f32 v106, v106
    v_exp_f32 v107, v107
    v_exp_f32 v108, v108
    v_exp_f32 v109, v109
    s_nop 0
    v_add_f32 v96, 1.0, v96
    v_add_f32 v97, 1.0, v97
    v_add_f32 v98, 1.0, v98
    v_add_f32 v99, 1.0, v99
    v_add_f32 v100, 1.0, v100
    v_add_f32 v101, 1.0, v101
    v_add_f32 v102, 1.0, v102
    v_add_f32 v103, 1.0, v103
    v_add_f32 v104, 1.0, v104
    v_add_f32 v105, 1.0, v105
    v_add_f32 v106, 1.0, v106
    v_add_f32 v107, 1.0, v107
    v_add_f32 v108, 1.0, v108
    v_add_f32 v109, 1.0, v109
    v_rcp_f32 v96, v96
    v_rcp_f32 v97, v97
    v_rcp_f32 v98, v98
    v_rcp_f32 v99, v99
    v_rcp_f32 v100, v100
    v_rcp_f32 v101, v101
    v_rcp_f32 v102, v102
    v_rcp_f32 v103, v103
    v_rcp_f32 v104, v104
    v_rcp_f32 v105, v105
    v_rcp_f32 v106, v106
    v_rcp_f32 v107, v107
    v_rcp_f32 v108, v108
    v_rcp_f32 v109, v109
    s_nop 0
    v_mul_f32 v80, v80, v96
    v_mul_f32 v81, v81, v97
    v_mul_f32 v82, v82, v98
    v_mul_f32 v83, v83, v99
    v_mul_f32 v84, v84, v100
    v_mul_f32 v85, v85, v101
    v_mul_f32 v86, v86, v102
    v_mul_f32 v87, v87, v103
    v_mul_f32 v88, v88, v104
    v_mul_f32 v89, v89, v105
    v_mul_f32 v90, v90, v106
    v_mul_f32 v91, v91, v107
    v_mul_f32 v92, v92, v108
    v_mul_f32 v93, v93, v109
    v_cvt_pk_bf16_f32 v96, v80, v81
    v_lshlrev_b32 v80, 16, v96
    v_and_b32 v81, 0xffff0000, v96
    v_cvt_pk_bf16_f32 v97, v82, v83
    v_lshlrev_b32 v82, 16, v97
    v_and_b32 v83, 0xffff0000, v97
    v_cvt_pk_bf16_f32 v98, v84, v85
    v_lshlrev_b32 v84, 16, v98
    v_and_b32 v85, 0xffff0000, v98
    v_cvt_pk_bf16_f32 v99, v86, v87
    v_lshlrev_b32 v86, 16, v99
    v_and_b32 v87, 0xffff0000, v99
    v_cvt_pk_bf16_f32 v100, v88, v89
    v_lshlrev_b32 v88, 16, v100
    v_and_b32 v89, 0xffff0000, v100
    v_cvt_pk_bf16_f32 v101, v90, v91
    v_lshlrev_b32 v90, 16, v101
    v_and_b32 v91, 0xffff0000, v101
    v_cvt_pk_bf16_f32 v102, v92, v93
    v_lshlrev_b32 v92, 16, v102
    v_and_b32 v93, 0xffff0000, v102
    v_mov_b32 v112, 0
    v_mov_b32 v113, 0
    v_mov_b32 v114, 0
    v_mov_b32 v115, 0
    v_mov_b32 v116, 0
    v_mov_b32 v117, 0
    v_mov_b32 v118, 0
    v_mov_b32 v119, 0
    s_waitcnt vmcnt(13)
    v_lshlrev_b32 v120, 16, v20
    v_and_b32 v121, 0xffff0000, v20
    v_lshlrev_b32 v122, 16, v21
    v_and_b32 v123, 0xffff0000, v21
    v_lshlrev_b32 v124, 16, v22
    v_and_b32 v125, 0xffff0000, v22
    v_lshlrev_b32 v126, 16, v23
    v_and_b32 v127, 0xffff0000, v23
    v_fmac_f32 v112, v80, v120
    v_fmac_f32 v113, v80, v121
    v_fmac_f32 v114, v80, v122
    v_fmac_f32 v115, v80, v123
    v_fmac_f32 v116, v80, v124
    v_fmac_f32 v117, v80, v125
    v_fmac_f32 v118, v80, v126
    v_fmac_f32 v119, v80, v127
    s_waitcnt vmcnt(12)
    v_lshlrev_b32 v120, 16, v24
    v_and_b32 v121, 0xffff0000, v24
    v_lshlrev_b32 v122, 16, v25
    v_and_b32 v123, 0xffff0000, v25
    v_lshlrev_b32 v124, 16, v26
    v_and_b32 v125, 0xffff0000, v26
    v_lshlrev_b32 v126, 16, v27
    v_and_b32 v127, 0xffff0000, v27
    v_fmac_f32 v112, v81, v120
    v_fmac_f32 v113, v81, v121
    v_fmac_f32 v114, v81, v122
    v_fmac_f32 v115, v81, v123
    v_fmac_f32 v116, v81, v124
    v_fmac_f32 v117, v81, v125
    v_fmac_f32 v118, v81, v126
    v_fmac_f32 v119, v81, v127
    s_waitcnt vmcnt(11)
    v_lshlrev_b32 v120, 16, v28
    v_and_b32 v121, 0xffff0000, v28
    v_lshlrev_b32 v122, 16, v29
    v_and_b32 v123, 0xffff0000, v29
    v_lshlrev_b32 v124, 16, v30
    v_and_b32 v125, 0xffff0000, v30
    v_lshlrev_b32 v126, 16, v31
    v_and_b32 v127, 0xffff0000, v31
    v_fmac_f32 v112, v82, v120
    v_fmac_f32 v113, v82, v121
    v_fmac_f32 v114, v82, v122
    v_fmac_f32 v115, v82, v123
    v_fmac_f32 v116, v82, v124
    v_fmac_f32 v117, v82, v125
    v_fmac_f32 v118, v82, v126
    v_fmac_f32 v119, v82, v127
    s_waitcnt vmcnt(10)
    v_lshlrev_b32 v120, 16, v32
    v_and_b32 v121, 0xffff0000, v32
    v_lshlrev_b32 v122, 16, v33
    v_and_b32 v123, 0xffff0000, v33
    v_lshlrev_b32 v124, 16, v34
    v_and_b32 v125, 0xffff0000, v34
    v_lshlrev_b32 v126, 16, v35
    v_and_b32 v127, 0xffff0000, v35
    v_fmac_f32 v112, v83, v120
    v_fmac_f32 v113, v83, v121
    v_fmac_f32 v114, v83, v122
    v_fmac_f32 v115, v83, v123
    v_fmac_f32 v116, v83, v124
    v_fmac_f32 v117, v83, v125
    v_fmac_f32 v118, v83, v126
    v_fmac_f32 v119, v83, v127
    s_waitcnt vmcnt(9)
    v_lshlrev_b32 v120, 16, v36
    v_and_b32 v121, 0xffff0000, v36
    v_lshlrev_b32 v122, 16, v37
    v_and_b32 v123, 0xffff0000, v37
    v_lshlrev_b32 v124, 16, v38
    v_and_b32 v125, 0xffff0000, v38
    v_lshlrev_b32 v126, 16, v39
    v_and_b32 v127, 0xffff0000, v39
    v_fmac_f32 v112, v84, v120
    v_fmac_f32 v113, v84, v121
    v_fmac_f32 v114, v84, v122
    v_fmac_f32 v115, v84, v123
    v_fmac_f32 v116, v84, v124
    v_fmac_f32 v117, v84, v125
    v_fmac_f32 v118, v84, v126
    v_fmac_f32 v119, v84, v127
    s_waitcnt vmcnt(8)
    v_lshlrev_b32 v120, 16, v40
    v_and_b32 v121, 0xffff0000, v40
    v_lshlrev_b32 v122, 16, v41
    v_and_b32 v123, 0xffff0000, v41
    v_lshlrev_b32 v124, 16, v42
    v_and_b32 v125, 0xffff0000, v42
    v_lshlrev_b32 v126, 16, v43
    v_and_b32 v127, 0xffff0000, v43
    v_fmac_f32 v112, v85, v120
    v_fmac_f32 v113, v85, v121
    v_fmac_f32 v114, v85, v122
    v_fmac_f32 v115, v85, v123
    v_fmac_f32 v116, v85, v124
    v_fmac_f32 v117, v85, v125
    v_fmac_f32 v118, v85, v126
    v_fmac_f32 v119, v85, v127
    s_waitcnt vmcnt(7)
    v_lshlrev_b32 v120, 16, v44
    v_and_b32 v121, 0xffff0000, v44
    v_lshlrev_b32 v122, 16, v45
    v_and_b32 v123, 0xffff0000, v45
    v_lshlrev_b32 v124, 16, v46
    v_and_b32 v125, 0xffff0000, v46
    v_lshlrev_b32 v126, 16, v47
    v_and_b32 v127, 0xffff0000, v47
    v_fmac_f32 v112, v86, v120
    v_fmac_f32 v113, v86, v121
    v_fmac_f32 v114, v86, v122
    v_fmac_f32 v115, v86, v123
    v_fmac_f32 v116, v86, v124
    v_fmac_f32 v117, v86, v125
    v_fmac_f32 v118, v86, v126
    v_fmac_f32 v119, v86, v127
    s_waitcnt vmcnt(6)
    v_lshlrev_b32 v120, 16, v48
    v_and_b32 v121, 0xffff0000, v48
    v_lshlrev_b32 v122, 16, v49
    v_and_b32 v123, 0xffff0000, v49
    v_lshlrev_b32 v124, 16, v50
    v_and_b32 v125, 0xffff0000, v50
    v_lshlrev_b32 v126, 16, v51
    v_and_b32 v127, 0xffff0000, v51
    v_fmac_f32 v112, v87, v120
    v_fmac_f32 v113, v87, v121
    v_fmac_f32 v114, v87, v122
    v_fmac_f32 v115, v87, v123
    v_fmac_f32 v116, v87, v124
    v_fmac_f32 v117, v87, v125
    v_fmac_f32 v118, v87, v126
    v_fmac_f32 v119, v87, v127
    s_waitcnt vmcnt(5)
    v_lshlrev_b32 v120, 16, v52
    v_and_b32 v121, 0xffff0000, v52
    v_lshlrev_b32 v122, 16, v53
    v_and_b32 v123, 0xffff0000, v53
    v_lshlrev_b32 v124, 16, v54
    v_and_b32 v125, 0xffff0000, v54
    v_lshlrev_b32 v126, 16, v55
    v_and_b32 v127, 0xffff0000, v55
    v_fmac_f32 v112, v88, v120
    v_fmac_f32 v113, v88, v121
    v_fmac_f32 v114, v88, v122
    v_fmac_f32 v115, v88, v123
    v_fmac_f32 v116, v88, v124
    v_fmac_f32 v117, v88, v125
    v_fmac_f32 v118, v88, v126
    v_fmac_f32 v119, v88, v127
    s_waitcnt vmcnt(4)
    v_lshlrev_b32 v120, 16, v56
    v_and_b32 v121, 0xffff0000, v56
    v_lshlrev_b32 v122, 16, v57
    v_and_b32 v123, 0xffff0000, v57
    v_lshlrev_b32 v124, 16, v58
    v_and_b32 v125, 0xffff0000, v58
    v_lshlrev_b32 v126, 16, v59
    v_and_b32 v127, 0xffff0000, v59
    v_fmac_f32 v112, v89, v120
    v_fmac_f32 v113, v89, v121
    v_fmac_f32 v114, v89, v122
    v_fmac_f32 v115, v89, v123
    v_fmac_f32 v116, v89, v124
    v_fmac_f32 v117, v89, v125
    v_fmac_f32 v118, v89, v126
    v_fmac_f32 v119, v89, v127
    s_waitcnt vmcnt(3)
    v_lshlrev_b32 v120, 16, v60
    v_and_b32 v121, 0xffff0000, v60
    v_lshlrev_b32 v122, 16, v61
    v_and_b32 v123, 0xffff0000, v61
    v_lshlrev_b32 v124, 16, v62
    v_and_b32 v125, 0xffff0000, v62
    v_lshlrev_b32 v126, 16, v63
    v_and_b32 v127, 0xffff0000, v63
    v_fmac_f32 v112, v90, v120
    v_fmac_f32 v113, v90, v121
    v_fmac_f32 v114, v90, v122
    v_fmac_f32 v115, v90, v123
    v_fmac_f32 v116, v90, v124
    v_fmac_f32 v117, v90, v125
    v_fmac_f32 v118, v90, v126
    v_fmac_f32 v119, v90, v127
    s_waitcnt vmcnt(2)
    v_lshlrev_b32 v120, 16, v64
    v_and_b32 v121, 0xffff0000, v64
    v_lshlrev_b32 v122, 16, v65
    v_and_b32 v123, 0xffff0000, v65
    v_lshlrev_b32 v124, 16, v66
    v_and_b32 v125, 0xffff0000, v66
    v_lshlrev_b32 v126, 16, v67
    v_and_b32 v127, 0xffff0000, v67
    v_fmac_f32 v112, v91, v120
    v_fmac_f32 v113, v91, v121
    v_fmac_f32 v114, v91, v122
    v_fmac_f32 v115, v91, v123
    v_fmac_f32 v116, v91, v124
    v_fmac_f32 v117, v91, v125
    v_fmac_f32 v118, v91, v126
    v_fmac_f32 v119, v91, v127
    s_waitcnt vmcnt(1)
    v_lshlrev_b32 v120, 16, v68
    v_and_b32 v121, 0xffff0000, v68
    v_lshlrev_b32 v122, 16, v69
    v_and_b32 v123, 0xffff0000, v69
    v_lshlrev_b32 v124, 16, v70
    v_and_b32 v125, 0xffff0000, v70
    v_lshlrev_b32 v126, 16, v71
    v_and_b32 v127, 0xffff0000, v71
    v_fmac_f32 v112, v92, v120
    v_fmac_f32 v113, v92, v121
    v_fmac_f32 v114, v92, v122
    v_fmac_f32 v115, v92, v123
    v_fmac_f32 v116, v92, v124
    v_fmac_f32 v117, v92, v125
    v_fmac_f32 v118, v92, v126
    v_fmac_f32 v119, v92, v127
    s_waitcnt vmcnt(0)
    v_lshlrev_b32 v120, 16, v72
    v_and_b32 v121, 0xffff0000, v72
    v_lshlrev_b32 v122, 16, v73
    v_and_b32 v123, 0xffff0000, v73
    v_lshlrev_b32 v124, 16, v74
    v_and_b32 v125, 0xffff0000, v74
    v_lshlrev_b32 v126, 16, v75
    v_and_b32 v127, 0xffff0000, v75
    v_fmac_f32 v112, v93, v120
    v_fmac_f32 v113, v93, v121
    v_fmac_f32 v114, v93, v122
    v_fmac_f32 v115, v93, v123
    v_fmac_f32 v116, v93, v124
    v_fmac_f32 v117, v93, v125
    v_fmac_f32 v118, v93, v126
    v_fmac_f32 v119, v93, v127
    v_lshlrev_b32 v5, 5, v0
    ds_write_b128 v5, v[112:115]
    ds_write_b128 v5, v[116:119] offset:16
    s_waitcnt lgkmcnt(0)
MOD_2IDLE:
    s_barrier
    s_cmp_ge_u32 s3, 2
    s_cbranch_scc1 MOD_2END
    v_lshlrev_b32 v5, 2, v0
    ds_read_b32 v20, v5 offset:0
    ds_read_b32 v21, v5 offset:384
    ds_read_b32 v22, v5 offset:768
    ds_read_b32 v23, v5 offset:1152
    ds_read_b32 v24, v5 offset:1536
    ds_read_b32 v25, v5 offset:1920
    ds_read_b32 v26, v5 offset:2304
    ds_read_b32 v27, v5 offset:2688
    ds_read_b32 v28, v5 offset:3072
    ds_read_b32 v29, v5 offset:3456
    ds_read_b32 v30, v5 offset:3840
    ds_read_b32 v31, v5 offset:4224
    ds_read_b32 v32, v5 offset:4608
    ds_read_b32 v33, v5 offset:4992
    ds_read_b32 v34, v5 offset:5376
    ds_read_b32 v35, v5 offset:5760
    ds_read_b32 v36, v5 offset:6144
    ds_read_b32 v37, v5 offset:6528
    ds_read_b32 v38, v5 offset:6912
    ds_read_b32 v39, v5 offset:7296
    ds_read_b32 v40, v5 offset:7680
    ds_read_b32 v41, v5 offset:8064
    ds_read_b32 v42, v5 offset:8448
    ds_read_b32 v43, v5 offset:8832
    ds_read_b32 v44, v5 offset:9216
    ds_read_b32 v45, v5 offset:9600
    ds_read_b32 v46, v5 offset:9984
    ds_read_b32 v47, v5 offset:10368
    ds_read_b32 v48, v5 offset:10752
    ds_read_b32 v49, v5 offset:11136
    ds_read_b32 v50, v5 offset:11520
    ds_read_b32 v51, v5 offset:11904
    s_waitcnt lgkmcnt(0)
    v_add_f32 v20, v20, v36
    v_add_f32 v21, v21, v37
    v_add_f32 v22, v22, v38
    v_add_f32 v23, v23, v39
    v_add_f32 v24, v24, v40
    v_add_f32 v25, v25, v41
    v_add_f32 v26, v26, v42
    v_add_f32 v27, v27, v43
    v_add_f32 v28, v28, v44
    v_add_f32 v29, v29, v45
    v_add_f32 v30, v30, v46
    v_add_f32 v31, v31, v47
    v_add_f32 v32, v32, v48
    v_add_f32 v33, v33, v49
    v_add_f32 v34, v34, v50
    v_add_f32 v35, v35, v51
    v_add_f32 v20, v20, v28
    v_add_f32 v21, v21, v29
    v_add_f32 v22, v22, v30
    v_add_f32 v23, v23, v31
    v_add_f32 v24, v24, v32
    v_add_f32 v25, v25, v33
    v_add_f32 v26, v26, v34
    v_add_f32 v27, v27, v35
    v_add_f32 v20, v20, v24
    v_add_f32 v21, v21, v25
    v_add_f32 v22, v22, v26
    v_add_f32 v23, v23, v27
    v_add_f32 v20, v20, v22
    v_add_f32 v21, v21, v23
    v_add_f32 v20, v20, v21
    v_cvt_pk_bf16_f32 v21, v20, v20
    v_lshlrev_b32 v22, 16, v21
    v_add_f32 v22, 1.0, v22
    v_cvt_pk_bf16_f32 v22, v22, v22
    s_lshr_b32 s33, s31, 1
    v_add_u32 v6, s33, v0
    v_subrev_u32 v7, 448, v6
    v_subrev_u32 v8, 1792, v6
    v_min_u32 v7, v7, v8
    v_cmp_gt_u32 vcc, 448, v7
    s_nop 1
    v_cndmask_b32 v21, v21, v22, vcc
    v_and_b32 v21, 0xffff, v21
    s_nop 1
    v_mov_b32_dpp v22, v21 quad_perm:[1,0,3,2] row_mask:0xf bank_mask:0xf
    v_lshl_or_b32 v21, v22, 16, v21
    v_lshlrev_b32 v6, 1, v6
    v_and_b32 v7, 1, v0
    v_cmp_eq_u32 s[36:37], 0, v7
    v_cmp_gt_u32 vcc, 96, v0
    s_and_b64 exec, vcc, s[36:37]
    buffer_store_dword v21, v6, s[20:23], 0 offen sc1
    s_mov_b64 exec, -1
MOD_2END:
M_P0DONE:
    s_mov_b32 s72, s44
    s_and_b32 s73, s45, 0xffff
    s_mov_b32 s74, 0x100
    s_mov_b32 s75, 0x00020000
    s_bfe_u32 s59, s2, 0x10003
    s_lshl_b32 s59, s59, 6
    s_add_u32 s59, s59, 128
    s_waitcnt lgkmcnt(0)
    s_cmp_lg_u32 s3, 3
    s_cbranch_scc1 WT_3
    v_and_b32 v1, 63, v0
    v_lshlrev_b32 v1, 2, v1
    s_mov_b64 exec, 0x3
    s_mov_b32 s60, 200000
    buffer_load_dword v4, v1, s[72:75], s59 offen sc1
    s_sleep 3
WT_3P:
    buffer_load_dword v5, v1, s[72:75], s59 offen sc1
    s_waitcnt vmcnt(1)
    v_cmp_eq_u32 vcc, 0, v4
    s_cbranch_vccz WT_3D
    s_sleep 3
    buffer_load_dword v4, v1, s[72:75], s59 offen sc1
    s_waitcnt vmcnt(1)
    v_cmp_eq_u32 vcc, 0, v5
    s_cbranch_vccz WT_3D
    s_sleep 3
    s_sub_u32 s60, s60, 1
    s_cmp_lg_u32 s60, 0
    s_cbranch_scc1 WT_3P
WT_3D:
    s_waitcnt vmcnt(0)
    s_mov_b64 exec, -1
WT_3:
    s_barrier
    s_cmp_ge_u32 s2, 224
    s_cbranch_scc1 M_SPARE2
    s_load_dwordx2 s[24:25], s[0:1], 40
    s_lshr_b32 s29, s3, 2
    s_add_u32 s30, s47, s29
    s_and_b32 s31, s3, 3
    s_mul_i32 s28, s29, 43008
    v_and_b32 v1, 255, v0
    s_lshl_b32 s32, s30, 12
    v_lshlrev_b32 v2, 4, v1
    s_add_u32 s35, s32, 0x10000
    buffer_load_dwordx4 v[4:7], v2, s[20:23], s35 offen sc1
    s_waitcnt lgkmcnt(0)
    s_lshl_b32 s33, s30, 1
    s_and_b32 s33, s33, 0xfffffffc
    s_add_u32 s24, s24, s33
    s_addc_u32 s25, s25, 0
    s_load_dword s34, s[24:25], 0
    v_lshrrev_b32 v12, 2, v1
    v_mul_u32_u24 v12, 80, v12
    v_and_b32 v11, 3, v1
    v_lshl_add_u32 v12, v11, 4, v12
    v_add_u32 v12, s28, v12
    v_and_b32 v8, 31, v0
    v_bfe_u32 v9, v0, 5, 1
    v_and_b32 v10, 7, v8
    v_lshrrev_b32 v11, 3, v8
    s_movk_i32 s38, 4416
    v_mul_lo_u32 v10, v10, s38
    v_add_u32 v11, v11, v9
    v_lshl_add_u32 v10, v11, 4, v10
    s_lshl_b32 s39, s31, 9
    s_add_u32 s39, s39, s28
    v_add_u32 v10, s39, v10
    s_lshl_b32 s39, s31, 3
    s_sub_u32 s39, 25, s39
    v_add_u32 v11, s39, v8
    v_mul_u32_u24 v11, 80, v11
    v_lshl_add_u32 v11, v9, 4, v11
    s_add_u32 s39, s28, 35328
    v_add_u32 v11, s39, v11
    s_waitcnt vmcnt(0)
    ds_write_b128 v12, v[4:7] offset:37888
    s_waitcnt lgkmcnt(0)
    s_barrier
    s_load_dwordx2 s[78:79], s[0:1], 0
    v_lshrrev_b32 v48, 6, v0
    v_and_b32 v49, 63, v0
    v_lshlrev_b32 v50, 4, v49
    v_cmp_gt_u32 s[76:77], 56, v49
    s_lshl_b32 s75, s63, 3
    v_add_u32 v51, s75, v48
    s_movk_i32 s75, 896
    v_mul_lo_u32 v51, v51, s75
    v_add_u32 v51, v51, v50
    v_mov_b32 v16, 0
    v_mov_b32 v17, 0
    v_mov_b32 v18, 0
    v_mov_b32 v19, 0
    v_mov_b32 v20, 0
    v_mov_b32 v21, 0
    v_mov_b32 v22, 0
    v_mov_b32 v23, 0
    v_mov_b32 v24, 0
    v_mov_b32 v25, 0
    v_mov_b32 v26, 0
    v_mov_b32 v27, 0
    v_mov_b32 v28, 0
    v_mov_b32 v29, 0
    v_mov_b32 v30, 0
    v_mov_b32 v31, 0
    v_mov_b32 v32, 0
    v_mov_b32 v33, 0
    v_mov_b32 v34, 0
    v_mov_b32 v35, 0
    v_mov_b32 v36, 0
    v_mov_b32 v37, 0
    v_mov_b32 v38, 0
    v_mov_b32 v39, 0
    s_waitcnt lgkmcnt(0)
    s_mov_b32 s80, s78
    s_and_b32 s81, s79, 0xffff
    s_mov_b32 s82, 0x1c0000
    s_mov_b32 s83, 0x00020000
    s_mov_b64 exec, s[76:77]
    buffer_load_dwordx4 v[16:19], v51, s[80:83], 0 offen
    s_mov_b64 exec, -1
    s_mov_b32 s97, 0
    s_sub_u32 s27, s3, 4
    s_cmp_ge_u32 s27, 2
    s_cbranch_scc1 CV_NOREP
    s_mul_i32 s27, s27, 224
    s_add_u32 s27, s27, s2
    s_load_dwordx2 s[84:85], s[0:1], 56
    s_load_dwordx2 s[86:87], s[0:1], 64
    s_load_dwordx2 s[82:83], s[0:1], 72
    s_mov_b32 s97, 0
    v_and_b32 v240, 63, v0
    s_waitcnt lgkmcnt(0)
    s_cmp_ge_u32 s27, 196
    s_cbranch_scc1 RPL_4W
    s_mov_b32 s97, 1
    s_mov_b32 s96, 0x24924925
    s_mul_hi_u32 s98, s27, s96
    s_mul_i32 s99, s98, 7
    s_sub_u32 s99, s27, s99
    v_and_b32 v241, 31, v240
    v_lshrrev_b32 v242, 5, v240
    s_lshl_b32 s96, s99, 5
    v_add_u32 v243, s96, v241
    s_lshl_b32 s96, s98, 1
    v_add_u32 v244, s96, v242
    s_mov_b32 s96, 28672
    v_mul_lo_u32 v244, v244, s96
    v_lshl_add_u32 v244, v243, 4, v244
    s_mov_b32 s88, s84
    s_and_b32 s89, s85, 0xffff
    s_mov_b32 s90, 0x188000
    s_mov_b32 s91, 0x00020000
    s_mov_b32 s92, s86
    s_and_b32 s93, s87, 0xffff
    s_mov_b32 s94, 0x188000
    s_mov_b32 s95, 0x00020000
    s_mov_b32 s96, 0
    buffer_load_dwordx4 v[144:147], v244, s[88:91], s96 offen
    buffer_load_dwordx4 v[176:179], v244, s[92:95], s96 offen
    s_add_u32 s96, s96, 3584
    buffer_load_dwordx4 v[148:151], v244, s[88:91], s96 offen
    buffer_load_dwordx4 v[180:183], v244, s[92:95], s96 offen
    s_add_u32 s96, s96, 3584
    buffer_load_dwordx4 v[152:155], v244, s[88:91], s96 offen
    buffer_load_dwordx4 v[184:187], v244, s[92:95], s96 offen
    s_add_u32 s96, s96, 3584
    buffer_load_dwordx4 v[156:159], v244, s[88:91], s96 offen
    buffer_load_dwordx4 v[188:191], v244, s[92:95], s96 offen
    s_add_u32 s96, s96, 3584
    buffer_load_dwordx4 v[160:163], v244, s[88:91], s96 offen
    buffer_load_dwordx4 v[192:195], v244, s[92:95], s96 offen
    s_add_u32 s96, s96, 3584
    buffer_load_dwordx4 v[164:167], v244, s[88:91], s96 offen
    buffer_load_dwordx4 v[196:199], v244, s[92:95], s96 offen
    s_add_u32 s96, s96, 3584
    buffer_load_dwordx4 v[168:171], v244, s[88:91], s96 offen
    buffer_load_dwordx4 v[200:203], v244, s[92:95], s96 offen
    s_add_u32 s96, s96, 3584
    buffer_load_dwordx4 v[172:175], v244, s[88:91], s96 offen
    buffer_load_dwordx4 v[204:207], v244, s[92:95], s96 offen
    s_add_u32 s96, s96, 3584
RPL_4W:
    s_sub_u32 s26, s27, 196
    s_cmp_ge_u32 s26, 196
    s_cbranch_scc1 RPL_4E
    s_or_b32 s97, s97, 2
    s_mov_b32 s96, 0x24924925
    s_mul_hi_u32 s100, s26, s96
    s_mul_i32 s101, s100, 7
    s_sub_u32 s101, s26, s101
    v_and_b32 v241, 7, v240
    v_lshrrev_b32 v242, 3, v240
    s_lshl_b32 s96, s101, 3
    v_add_u32 v243, s96, v241
    s_lshl_b32 s96, s100, 3
    v_add_u32 v244, s96, v242
    v_lshrrev_b32 v245, 1, v244
    v_and_b32 v244, 1, v244
    v_lshlrev_b32 v245, 4, v245
    v_lshl_add_u32 v244, v244, 2, v245
    s_movk_i32 s96, 896
    v_mul_lo_u32 v244, v244, s96
    v_lshl_add_u32 v244, v243, 4, v244
    s_mov_b32 s88, s82
    s_and_b32 s89, s83, 0xffff
    s_mov_b32 s90, 0x188000
    s_mov_b32 s91, 0x00020000
    s_movk_i32 s96, 7168
    buffer_load_dwordx4 v[208:211], v244, s[88:91], 0 offen offset:0
    buffer_load_dwordx4 v[212:215], v244, s[88:91], 0 offen offset:896
    buffer_load_dwordx4 v[216:219], v244, s[88:91], 0 offen offset:1792
    buffer_load_dwordx4 v[220:223], v244, s[88:91], 0 offen offset:2688
    buffer_load_dwordx4 v[224:227], v244, s[88:91], s96 offen offset:0
    buffer_load_dwordx4 v[228:231], v244, s[88:91], s96 offen offset:896
    buffer_load_dwordx4 v[232:235], v244, s[88:91], s96 offen offset:1792
    buffer_load_dwordx4 v[236:239], v244, s[88:91], s96 offen offset:2688
RPL_4E:
CV_NOREP:
    ds_read_b128 v[112:115], v10 offset:32
    ds_read_b128 v[120:123], v11 offset:592
    ds_read_b128 v[116:119], v10 offset:2080
    ds_read_b128 v[124:127], v11 offset:3152
    ds_read_b128 v[128:131], v10 offset:0
    ds_read_b128 v[136:139], v11 offset:560
    ds_read_b128 v[132:135], v10 offset:2048
    ds_read_b128 v[140:143], v11 offset:3120
    s_waitcnt lgkmcnt(4)
    v_mfma_f32_32x32x16_bf16 v[64:79], v[112:115], v[120:123], 0
    v_mfma_f32_32x32x16_bf16 v[80:95], v[116:119], v[120:123], 0
    v_mfma_f32_32x32x16_bf16 v[96:111], v[112:115], v[124:127], 0
    ds_read_b128 v[112:115], v10 offset:96
    ds_read_b128 v[120:123], v11 offset:512
    ds_read_b128 v[116:119], v10 offset:2144
    ds_read_b128 v[124:127], v11 offset:3072
    s_waitcnt lgkmcnt(4)
    v_mfma_f32_32x32x16_bf16 v[64:79], v[128:131], v[136:139], v[64:79]
    v_mfma_f32_32x32x16_bf16 v[80:95], v[132:135], v[136:139], v[80:95]
    v_mfma_f32_32x32x16_bf16 v[96:111], v[128:131], v[140:143], v[96:111]
    ds_read_b128 v[128:131], v10 offset:64
    ds_read_b128 v[136:139], v11 offset:480
    ds_read_b128 v[132:135], v10 offset:2112
    ds_read_b128 v[140:143], v11 offset:3040
    s_waitcnt lgkmcnt(4)
    v_mfma_f32_32x32x16_bf16 v[64:79], v[112:115], v[120:123], v[64:79]
    v_mfma_f32_32x32x16_bf16 v[80:95], v[116:119], v[120:123], v[80:95]
    v_mfma_f32_32x32x16_bf16 v[96:111], v[112:115], v[124:127], v[96:111]
    ds_read_b128 v[112:115], v10 offset:160
    ds_read_b128 v[120:123], v11 offset:432
    ds_read_b128 v[116:119], v10 offset:2208
    ds_read_b128 v[124:127], v11 offset:2992
    s_waitcnt lgkmcnt(4)
    v_mfma_f32_32x32x16_bf16 v[64:79], v[128:131], v[136:139], v[64:79]
    v_mfma_f32_32x32x16_bf16 v[80:95], v[132:135], v[136:139], v[80:95]
    v_mfma_f32_32x32x16_bf16 v[96:111], v[128:131], v[140:143], v[96:111]
    ds_read_b128 v[128:131], v10 offset:128
    ds_read_b128 v[136:139], v11 offset:400
    ds_read_b128 v[132:135], v10 offset:2176
    ds_read_b128 v[140:143], v11 offset:2960
    s_waitcnt lgkmcnt(4)
    v_mfma_f32_32x32x16_bf16 v[64:79], v[112:115], v[120:123], v[64:79]
    v_mfma_f32_32x32x16_bf16 v[80:95], v[116:119], v[120:123], v[80:95]
    v_mfma_f32_32x32x16_bf16 v[96:111], v[112:115], v[124:127], v[96:111]
    ds_read_b128 v[112:115], v10 offset:224
    ds_read_b128 v[120:123], v11 offset:352
    ds_read_b128 v[116:119], v10 offset:2272
    ds_read_b128 v[124:127], v11 offset:2912
    s_waitcnt lgkmcnt(4)
    v_mfma_f32_32x32x16_bf16 v[64:79], v[128:131], v[136:139], v[64:79]
    v_mfma_f32_32x32x16_bf16 v[80:95], v[132:135], v[136:139], v[80:95]
    v_mfma_f32_32x32x16_bf16 v[96:111], v[128:131], v[140:143], v[96:111]
    ds_read_b128 v[128:131], v10 offset:192
    ds_read_b128 v[136:139], v11 offset:320
    ds_read_b128 v[132:135], v10 offset:2240
    ds_read_b128 v[140:143], v11 offset:2880
    s_waitcnt lgkmcnt(4)
    v_mfma_f32_32x32x16_bf16 v[64:79], v[112:115], v[120:123], v[64:79]
    v_mfma_f32_32x32x16_bf16 v[80:95], v[116:119], v[120:123], v[80:95]
    v_mfma_f32_32x32x16_bf16 v[96:111], v[112:115], v[124:127], v[96:111]
    ds_read_b128 v[112:115], v10 offset:288
    ds_read_b128 v[120:123], v11 offset:272
    ds_read_b128 v[116:119], v10 offset:2336
    ds_read_b128 v[124:127], v11 offset:2832
    s_waitcnt lgkmcnt(4)
    v_mfma_f32_32x32x16_bf16 v[64:79], v[128:131], v[136:139], v[64:79]
    v_mfma_f32_32x32x16_bf16 v[80:95], v[132:135], v[136:139], v[80:95]
    v_mfma_f32_32x32x16_bf16 v[96:111], v[128:131], v[140:143], v[96:111]
    ds_read_b128 v[128:131], v10 offset:256
    ds_read_b128 v[136:139], v11 offset:240
    ds_read_b128 v[132:135], v10 offset:2304
    ds_read_b128 v[140:143], v11 offset:2800
    s_waitcnt lgkmcnt(4)
    v_mfma_f32_32x32x16_bf16 v[64:79], v[112:115], v[120:123], v[64:79]
    v_mfma_f32_32x32x16_bf16 v[80:95], v[116:119], v[120:123], v[80:95]
    v_mfma_f32_32x32x16_bf16 v[96:111], v[112:115], v[124:127], v[96:111]
    ds_read_b128 v[112:115], v10 offset:352
    ds_read_b128 v[120:123], v11 offset:192
    ds_read_b128 v[116:119], v10 offset:2400
    ds_read_b128 v[124:127], v11 offset:2752
    s_waitcnt lgkmcnt(4)
    v_mfma_f32_32x32x16_bf16 v[64:79], v[128:131], v[136:139], v[64:79]
    v_mfma_f32_32x32x16_bf16 v[80:95], v[132:135], v[136:139], v[80:95]
    v_mfma_f32_32x32x16_bf16 v[96:111], v[128:131], v[140:143], v[96:111]
    s_and_b32 s59, s2, 31
    s_lshl_b32 s59, s59, 7
    s_add_u32 s59, s59, 0xe000
    s_cmp_lg_u32 s3, 7
    s_cbranch_scc1 FP_5
    v_mov_b32 v54, 0
    s_mov_b64 exec, 1
    buffer_load_dword v55, v54, s[20:23], s59 offen sc1
    s_mov_b64 exec, -1
FP_5:
    ds_read_b128 v[128:131], v10 offset:320
    ds_read_b128 v[136:139], v11 offset:160
    ds_read_b128 v[132:135], v10 offset:2368
    ds_read_b128 v[140:143], v11 offset:2720
    s_waitcnt lgkmcnt(4)
    v_mfma_f32_32x32x16_bf16 v[64:79], v[112:115], v[120:123], v[64:79]
    v_mfma_f32_32x32x16_bf16 v[80:95], v[116:119], v[120:123], v[80:95]
    v_mfma_f32_32x32x16_bf16 v[96:111], v[112:115], v[124:127], v[96:111]
    ds_read_b128 v[112:115], v10 offset:416
    ds_read_b128 v[120:123], v11 offset:112
    ds_read_b128 v[116:119], v10 offset:2464
    ds_read_b128 v[124:127], v11 offset:2672
    s_waitcnt lgkmcnt(4)
    v_mfma_f32_32x32x16_bf16 v[64:79], v[128:131], v[136:139], v[64:79]
    v_mfma_f32_32x32x16_bf16 v[80:95], v[132:135], v[136:139], v[80:95]
    v_mfma_f32_32x32x16_bf16 v[96:111], v[128:131], v[140:143], v[96:111]
    ds_read_b128 v[128:131], v10 offset:384
    ds_read_b128 v[136:139], v11 offset:80
    ds_read_b128 v[132:135], v10 offset:2432
    ds_read_b128 v[140:143], v11 offset:2640
    s_waitcnt lgkmcnt(4)
    v_mfma_f32_32x32x16_bf16 v[64:79], v[112:115], v[120:123], v[64:79]
    v_mfma_f32_32x32x16_bf16 v[80:95], v[116:119], v[120:123], v[80:95]
    v_mfma_f32_32x32x16_bf16 v[96:111], v[112:115], v[124:127], v[96:111]
    ds_read_b128 v[112:115], v10 offset:480
    ds_read_b128 v[120:123], v11 offset:32
    ds_read_b128 v[116:119], v10 offset:2528
    ds_read_b128 v[124:127], v11 offset:2592
    s_waitcnt lgkmcnt(4)
    v_mfma_f32_32x32x16_bf16 v[64:79], v[128:131], v[136:139], v[64:79]
    v_mfma_f32_32x32x16_bf16 v[80:95], v[132:135], v[136:139], v[80:95]
    v_mfma_f32_32x32x16_bf16 v[96:111], v[128:131], v[140:143], v[96:111]
    ds_read_b128 v[128:131], v10 offset:448
    ds_read_b128 v[136:139], v11 offset:0
    ds_read_b128 v[132:135], v10 offset:2496
    ds_read_b128 v[140:143], v11 offset:2560
    s_waitcnt lgkmcnt(4)
    v_mfma_f32_32x32x16_bf16 v[64:79], v[112:115], v[120:123], v[64:79]
    v_mfma_f32_32x32x16_bf16 v[80:95], v[116:119], v[120:123], v[80:95]
    v_mfma_f32_32x32x16_bf16 v[96:111], v[112:115], v[124:127], v[96:111]
    s_waitcnt lgkmcnt(0)
    v_mfma_f32_32x32x16_bf16 v[64:79], v[128:131], v[136:139], v[64:79]
    v_mfma_f32_32x32x16_bf16 v[80:95], v[132:135], v[136:139], v[80:95]
    v_mfma_f32_32x32x16_bf16 v[96:111], v[128:131], v[140:143], v[96:111]
    v_mul_u32_u24 v12, 144, v8
    v_lshl_add_u32 v12, v9, 4, v12
    s_mul_i32 s39, s31, 9216
    s_add_u32 s39, s39, s28
    v_add_u32 v12, s39, v12
    v_lshrrev_b32 v13, 2, v1
    v_and_b32 v14, 3, v1
    v_sub_u32 v14, 3, v14
    v_mul_u32_u24 v15, 144, v13
    v_lshl_add_u32 v15, v14, 5, v15
    v_add_u32 v15, s28, v15
    s_and_b32 s59, s2, 31
    s_lshl_b32 s59, s59, 7
    s_add_u32 s59, s59, 0xe000
    s_cmp_lg_u32 s3, 7
    s_cbranch_scc1 WT_6
    v_and_b32 v54, 63, v0
    v_lshlrev_b32 v54, 2, v54
    s_mov_b64 exec, 0x1
    s_mov_b32 s60, 200000
    s_waitcnt vmcnt(0)
    v_cmp_eq_u32 vcc, 0, v55
    s_cbranch_vccz WT_6D
    buffer_load_dword v55, v54, s[20:23], s59 offen sc1
    s_sleep 3
WT_6P:
    buffer_load_dword v56, v54, s[20:23], s59 offen sc1
    s_waitcnt vmcnt(1)
    v_cmp_eq_u32 vcc, 0, v55
    s_cbranch_vccz WT_6D
    s_sleep 3
    buffer_load_dword v55, v54, s[20:23], s59 offen sc1
    s_waitcnt vmcnt(1)
    v_cmp_eq_u32 vcc, 0, v56
    s_cbranch_vccz WT_6D
    s_sleep 3
    s_sub_u32 s60, s60, 1
    s_cmp_lg_u32 s60, 0
    s_cbranch_scc1 WT_6P
WT_6D:
    s_waitcnt vmcnt(0)
    s_mov_b64 exec, -1
WT_6:
    s_barrier
    s_mov_b64 exec, s[76:77]
    buffer_load_dwordx4 v[20:23], v50, s[20:23], 0 offen offset:0 sc1
    buffer_load_dwordx4 v[24:27], v50, s[20:23], 0 offen offset:896 sc1
    buffer_load_dwordx4 v[28:31], v50, s[20:23], 0 offen offset:1792 sc1
    buffer_load_dwordx4 v[32:35], v50, s[20:23], 0 offen offset:2688 sc1
    buffer_load_dwordx4 v[36:39], v50, s[20:23], 0 offen offset:3584 sc1
    s_mov_b64 exec, -1
    ds_write_b128 v12, v[64:67] offset:0
    ds_write_b128 v12, v[68:71] offset:32
    ds_write_b128 v12, v[72:75] offset:64
    ds_write_b128 v12, v[76:79] offset:96
    v_add_f32 v80, v80, v96
    v_add_f32 v81, v81, v97
    v_add_f32 v82, v82, v98
    v_add_f32 v83, v83, v99
    v_add_f32 v84, v84, v100
    v_add_f32 v85, v85, v101
    v_add_f32 v86, v86, v102
    v_add_f32 v87, v87, v103
    v_add_f32 v88, v88, v104
    v_add_f32 v89, v89, v105
    v_add_f32 v90, v90, v106
    v_add_f32 v91, v91, v107
    v_add_f32 v92, v92, v108
    v_add_f32 v93, v93, v109
    v_add_f32 v94, v94, v110
    v_add_f32 v95, v95, v111
    ds_write_b128 v12, v[80:83] offset:4608
    ds_write_b128 v12, v[84:87] offset:4640
    ds_write_b128 v12, v[88:91] offset:4672
    ds_write_b128 v12, v[92:95] offset:4704
    s_and_b32 s35, s30, 1
    s_lshl_b32 s35, s35, 4
    s_lshr_b32 s34, s34, s35
    s_lshl_b32 s34, s34, 16
    v_lshlrev_b32 v135, 16, v4
    v_and_b32 v134, 0xffff0000, v4
    v_lshlrev_b32 v133, 16, v5
    v_and_b32 v132, 0xffff0000, v5
    v_lshlrev_b32 v131, 16, v6
    v_and_b32 v130, 0xffff0000, v6
    v_lshlrev_b32 v129, 16, v7
    v_and_b32 v128, 0xffff0000, v7
    v_mul_f32 v128, s34, v128
    v_mul_f32 v129, s34, v129
    v_mul_f32 v130, s34, v130
    v_mul_f32 v131, s34, v131
    v_mul_f32 v132, s34, v132
    v_mul_f32 v133, s34, v133
    v_mul_f32 v134, s34, v134
    v_mul_f32 v135, s34, v135
    v_cvt_pk_bf16_f32 v136, v128, v129
    v_lshlrev_b32 v128, 16, v136
    v_and_b32 v129, 0xffff0000, v136
    v_cvt_pk_bf16_f32 v136, v130, v131
    v_lshlrev_b32 v130, 16, v136
    v_and_b32 v131, 0xffff0000, v136
    v_cvt_pk_bf16_f32 v136, v132, v133
    v_lshlrev_b32 v132, 16, v136
    v_and_b32 v133, 0xffff0000, v136
    v_cvt_pk_bf16_f32 v136, v134, v135
    v_lshlrev_b32 v134, 16, v136
    v_and_b32 v135, 0xffff0000, v136
    s_movk_i32 s38, 28672
    v_mul_lo_u32 v13, v13, s38
    v_lshl_add_u32 v13, v14, 4, v13
    s_lshl_b32 s39, s30, 6
    s_add_u32 s39, s39, 0x200000
    s_waitcnt lgkmcnt(0)
    s_barrier
    ds_read_b128 v[96:99], v15 offset:0
    ds_read_b128 v[100:103], v15 offset:16
    ds_read_b128 v[104:107], v15 offset:9216
    ds_read_b128 v[108:111], v15 offset:9232
    ds_read_b128 v[112:115], v15 offset:18432
    ds_read_b128 v[116:119], v15 offset:18448
    ds_read_b128 v[120:123], v15 offset:27648
    ds_read_b128 v[124:127], v15 offset:27664
    s_waitcnt lgkmcnt(0)
    v_add_f32 v96, v96, v104
    v_add_f32 v112, v112, v120
    v_add_f32 v97, v97, v105
    v_add_f32 v113, v113, v121
    v_add_f32 v98, v98, v106
    v_add_f32 v114, v114, v122
    v_add_f32 v99, v99, v107
    v_add_f32 v115, v115, v123
    v_add_f32 v100, v100, v108
    v_add_f32 v116, v116, v124
    v_add_f32 v101, v101, v109
    v_add_f32 v117, v117, v125
    v_add_f32 v102, v102, v110
    v_add_f32 v118, v118, v126
    v_add_f32 v103, v103, v111
    v_add_f32 v119, v119, v127
    v_add_f32 v96, v96, v112
    v_add_f32 v97, v97, v113
    v_add_f32 v98, v98, v114
    v_add_f32 v99, v99, v115
    v_add_f32 v100, v100, v116
    v_add_f32 v101, v101, v117
    v_add_f32 v102, v102, v118
    v_add_f32 v103, v103, v119
    v_cvt_pk_bf16_f32 v136, v96, v97
    v_lshlrev_b32 v96, 16, v136
    v_and_b32 v97, 0xffff0000, v136
    v_cvt_pk_bf16_f32 v136, v98, v99
    v_lshlrev_b32 v98, 16, v136
    v_and_b32 v99, 0xffff0000, v136
    v_cvt_pk_bf16_f32 v136, v100, v101
    v_lshlrev_b32 v100, 16, v136
    v_and_b32 v101, 0xffff0000, v136
    v_cvt_pk_bf16_f32 v136, v102, v103
    v_lshlrev_b32 v102, 16, v136
    v_and_b32 v103, 0xffff0000, v136
    v_add_f32 v96, v96, v128
    v_add_f32 v97, v97, v129
    v_add_f32 v98, v98, v130
    v_add_f32 v99, v99, v131
    v_add_f32 v100, v100, v132
    v_add_f32 v101, v101, v133
    v_add_f32 v102, v102, v134
    v_add_f32 v103, v103, v135
    v_cvt_pk_bf16_f32 v140, v96, v97
    v_cvt_pk_bf16_f32 v141, v98, v99
    v_cvt_pk_bf16_f32 v142, v100, v101
    v_cvt_pk_bf16_f32 v143, v102, v103
    buffer_store_dwordx4 v[140:143], v13, s[20:23], s39 offen sc1
    s_and_b32 s59, s2, 7
    s_lshl_b32 s59, s59, 7
    s_add_u32 s59, s59, 0x8000
    s_and_b32 s58, s2, 7
    s_lshl_b32 s58, s58, 2
    s_add_u32 s58, s58, 0xa000
    s_waitcnt vmcnt(0)
    s_barrier
    s_cmp_lg_u32 s3, 0
    s_cbranch_scc1 ARR_7B
    v_mov_b32 v1, 0
    v_mov_b32 v2, 1
    s_mov_b64 exec, 1
    buffer_atomic_add v2, v1, s[20:23], s59 offen sc0 sc1
    s_barrier
    s_waitcnt vmcnt(0)
    v_cmp_eq_u32 vcc, 27, v2
    s_cbranch_vccz ARR_7X
    s_mov_b64 exec, 0xffffffff
    v_lshlrev_b32 v1, 7, v0
    v_mov_b32 v2, 1
    buffer_store_dword v2, v1, s[20:23], s58 offen sc1
ARR_7X:
    s_mov_b64 exec, -1
    s_branch ARR_7E
ARR_7B:
    s_barrier
ARR_7E:
    s_branch M_A
M_SPARE2:
    s_mov_b32 s59, 0x9900
    s_mov_b32 s58, 0xe000
    s_waitcnt vmcnt(0)
    s_barrier
    s_cmp_lg_u32 s3, 0
    s_cbranch_scc1 ARR_8B
    v_mov_b32 v1, 0
    v_mov_b32 v2, 1
    s_mov_b64 exec, 1
    buffer_atomic_add v2, v1, s[20:23], s59 offen sc0 sc1
    s_barrier
    s_waitcnt vmcnt(0)
    v_cmp_eq_u32 vcc, 31, v2
    s_cbranch_vccz ARR_8X
    s_mov_b64 exec, 0xffffffff
    v_lshlrev_b32 v1, 7, v0
    v_mov_b32 v2, 1
    buffer_store_dword v2, v1, s[20:23], s58 offen sc1
ARR_8X:
    s_mov_b64 exec, -1
    s_branch ARR_8E
ARR_8B:
    s_barrier
ARR_8E:
    s_load_dwordx2 s[78:79], s[0:1], 0
    v_lshrrev_b32 v48, 6, v0
    v_and_b32 v49, 63, v0
    v_lshlrev_b32 v50, 4, v49
    v_cmp_gt_u32 s[76:77], 56, v49
    s_lshl_b32 s75, s63, 3
    v_add_u32 v51, s75, v48
    s_movk_i32 s75, 896
    v_mul_lo_u32 v51, v51, s75
    v_add_u32 v51, v51, v50
    v_mov_b32 v16, 0
    v_mov_b32 v17, 0
    v_mov_b32 v18, 0
    v_mov_b32 v19, 0
    v_mov_b32 v20, 0
    v_mov_b32 v21, 0
    v_mov_b32 v22, 0
    v_mov_b32 v23, 0
    v_mov_b32 v24, 0
    v_mov_b32 v25, 0
    v_mov_b32 v26, 0
    v_mov_b32 v27, 0
    v_mov_b32 v28, 0
    v_mov_b32 v29, 0
    v_mov_b32 v30, 0
    v_mov_b32 v31, 0
    v_mov_b32 v32, 0
    v_mov_b32 v33, 0
    v_mov_b32 v34, 0
    v_mov_b32 v35, 0
    v_mov_b32 v36, 0
    v_mov_b32 v37, 0
    v_mov_b32 v38, 0
    v_mov_b32 v39, 0
    s_waitcnt lgkmcnt(0)
    s_mov_b32 s80, s78
    s_and_b32 s81, s79, 0xffff
    s_mov_b32 s82, 0x1c0000
    s_mov_b32 s83, 0x00020000
    s_mov_b64 exec, s[76:77]
    buffer_load_dwordx4 v[16:19], v51, s[80:83], 0 offen
    s_mov_b64 exec, -1
    s_and_b32 s59, s2, 31
    s_lshl_b32 s59, s59, 7
    s_add_u32 s59, s59, 0xe000
    s_cmp_lg_u32 s3, 7
    s_cbranch_scc1 WT_9
    v_and_b32 v54, 63, v0
    v_lshlrev_b32 v54, 2, v54
    s_mov_b64 exec, 0x1
    s_mov_b32 s60, 200000
    buffer_load_dword v55, v54, s[20:23], s59 offen sc1
    s_sleep 3
WT_9P:
    buffer_load_dword v56, v54, s[20:23], s59 offen sc1
    s_waitcnt vmcnt(1)
    v_cmp_eq_u32 vcc, 0, v55
    s_cbranch_vccz WT_9D
    s_sleep 3
    buffer_load_dword v55, v54, s[20:23], s59 offen sc1
    s_waitcnt vmcnt(1)
    v_cmp_eq_u32 vcc, 0, v56
    s_cbranch_vccz WT_9D
    s_sleep 3
    s_sub_u32 s60, s60, 1
    s_cmp_lg_u32 s60, 0
    s_cbranch_scc1 WT_9P
WT_9D:
    s_waitcnt vmcnt(0)
    s_mov_b64 exec, -1
WT_9:
    s_barrier
    s_mov_b64 exec, s[76:77]
    buffer_load_dwordx4 v[20:23], v50, s[20:23], 0 offen offset:0 sc1
    buffer_load_dwordx4 v[24:27], v50, s[20:23], 0 offen offset:896 sc1
    buffer_load_dwordx4 v[28:31], v50, s[20:23], 0 offen offset:1792 sc1
    buffer_load_dwordx4 v[32:35], v50, s[20:23], 0 offen offset:2688 sc1
    buffer_load_dwordx4 v[36:39], v50, s[20:23], 0 offen offset:3584 sc1
    s_mov_b64 exec, -1
    s_waitcnt vmcnt(0)
M_A:
    v_lshrrev_b32 v125, 6, v0
    v_and_b32 v126, 63, v0
    v_lshlrev_b32 v127, 4, v126
    v_cmp_gt_u32 s[40:41], 56, v126
    s_mov_b32 s42, 0x3b124925
    s_mov_b32 s43, 0x3727c5ac
    s_lshl_b32 s30, s63, 3
    v_add_u32 v123, s30, v125
    s_movk_i32 s31, 896
    v_mul_lo_u32 v124, v123, s31
    v_add_u32 v124, v124, v127
    v_lshlrev_b32 v122, 6, v0
    v_lshlrev_b32 v6, 4, v0
    v_lshrrev_b32 v121, 3, v0
    v_lshl_add_u32 v121, v121, 4, v6
    v_mul_u32_u24 v120, 144, v126
    v_lshl_add_u32 v120, v125, 1, v120
    s_lshr_b32 s32, s63, 2
    s_mul_i32 s32, s32, 28672
    s_and_b32 s33, s63, 3
    s_lshl_b32 s33, s33, 4
    s_add_u32 s32, s32, s33
    s_add_u32 s48, s32, 0x200000
    v_mov_b32 v56, 0
    v_mov_b32 v57, 0
    v_mov_b32 v58, 0
    v_mov_b32 v59, 0
    v_mov_b32 v60, 0
    v_mov_b32 v61, 0
    v_mov_b32 v62, 0
    v_mov_b32 v63, 0
    v_lshlrev_b32 v40, 16, v16
    v_and_b32 v41, 0xffff0000, v16
    v_lshlrev_b32 v42, 16, v17
    v_and_b32 v43, 0xffff0000, v17
    v_lshlrev_b32 v44, 16, v18
    v_and_b32 v45, 0xffff0000, v18
    v_lshlrev_b32 v46, 16, v19
    v_and_b32 v47, 0xffff0000, v19
    v_lshlrev_b32 v64, 16, v20
    v_and_b32 v65, 0xffff0000, v20
    v_lshlrev_b32 v66, 16, v21
    v_and_b32 v67, 0xffff0000, v21
    v_lshlrev_b32 v68, 16, v22
    v_and_b32 v69, 0xffff0000, v22
    v_lshlrev_b32 v70, 16, v23
    v_and_b32 v71, 0xffff0000, v23
    v_lshlrev_b32 v72, 16, v24
    v_and_b32 v73, 0xffff0000, v24
    v_lshlrev_b32 v74, 16, v25
    v_and_b32 v75, 0xffff0000, v25
    v_lshlrev_b32 v76, 16, v26
    v_and_b32 v77, 0xffff0000, v26
    v_lshlrev_b32 v78, 16, v27
    v_and_b32 v79, 0xffff0000, v27
    v_lshlrev_b32 v80, 16, v28
    v_and_b32 v81, 0xffff0000, v28
    v_lshlrev_b32 v82, 16, v29
    v_and_b32 v83, 0xffff0000, v29
    v_lshlrev_b32 v84, 16, v30
    v_and_b32 v85, 0xffff0000, v30
    v_lshlrev_b32 v86, 16, v31
    v_and_b32 v87, 0xffff0000, v31
    v_lshlrev_b32 v88, 16, v32
    v_and_b32 v89, 0xffff0000, v32
    v_lshlrev_b32 v90, 16, v33
    v_and_b32 v91, 0xffff0000, v33
    v_lshlrev_b32 v92, 16, v34
    v_and_b32 v93, 0xffff0000, v34
    v_lshlrev_b32 v94, 16, v35
    v_and_b32 v95, 0xffff0000, v35
    v_lshlrev_b32 v96, 16, v36
    v_and_b32 v97, 0xffff0000, v36
    v_lshlrev_b32 v98, 16, v37
    v_and_b32 v99, 0xffff0000, v37
    v_lshlrev_b32 v100, 16, v38
    v_and_b32 v101, 0xffff0000, v38
    v_lshlrev_b32 v102, 16, v39
    v_and_b32 v103, 0xffff0000, v39
    v_add_f32 v104, v40, v41
    v_add_f32 v105, v42, v43
    v_add_f32 v106, v44, v45
    v_add_f32 v107, v46, v47
    v_add_f32 v104, v104, v105
    v_add_f32 v106, v106, v107
    v_add_f32 v104, v104, v106
    v_cndmask_b32 v104, 0, v104, s[40:41]
    s_nop 1
    v_add_f32_dpp v105, v104, v104 quad_perm:[1,0,3,2] row_mask:0xf bank_mask:0xf
    s_nop 1
    v_add_f32_dpp v104, v105, v105 quad_perm:[2,3,0,1] row_mask:0xf bank_mask:0xf
    s_nop 1
    v_add_f32_dpp v105, v104, v104 row_half_mirror row_mask:0xf bank_mask:0xf
    s_nop 1
    v_add_f32_dpp v104, v105, v105 row_mirror row_mask:0xf bank_mask:0xf
    s_nop 0
    v_readlane_b32 s44, v104, 0
    v_readlane_b32 s45, v104, 16
    v_readlane_b32 s46, v104, 32
    v_readlane_b32 s47, v104, 48
    s_nop 1
    v_mov_b32 v106, s44
    v_add_f32 v106, s45, v106
    v_mov_b32 v105, s46
    v_add_f32 v105, s47, v105
    v_add_f32 v106, v106, v105
    v_mul_f32 v106, s42, v106
    v_sub_f32 v48, v40, v106
    v_sub_f32 v49, v41, v106
    v_sub_f32 v50, v42, v106
    v_sub_f32 v51, v43, v106
    v_sub_f32 v52, v44, v106
    v_sub_f32 v53, v45, v106
    v_sub_f32 v54, v46, v106
    v_sub_f32 v55, v47, v106
    v_mul_f32 v104, v48, v48
    v_mul_f32 v105, v49, v49
    v_fmac_f32 v104, v50, v50
    v_fmac_f32 v105, v51, v51
    v_fmac_f32 v104, v52, v52
    v_fmac_f32 v105, v53, v53
    v_fmac_f32 v104, v54, v54
    v_fmac_f32 v105, v55, v55
    v_add_f32 v104, v104, v105
    v_cndmask_b32 v104, 0, v104, s[40:41]
    s_nop 1
    v_add_f32_dpp v105, v104, v104 quad_perm:[1,0,3,2] row_mask:0xf bank_mask:0xf
    s_nop 1
    v_add_f32_dpp v104, v105, v105 quad_perm:[2,3,0,1] row_mask:0xf bank_mask:0xf
    s_nop 1
    v_add_f32_dpp v105, v104, v104 row_half_mirror row_mask:0xf bank_mask:0xf
    s_nop 1
    v_add_f32_dpp v104, v105, v105 row_mirror row_mask:0xf bank_mask:0xf
    s_nop 0
    v_readlane_b32 s44, v104, 0
    v_readlane_b32 s45, v104, 16
    v_readlane_b32 s46, v104, 32
    v_readlane_b32 s47, v104, 48
    s_nop 1
    v_mov_b32 v107, s44
    v_add_f32 v107, s45, v107
    v_mov_b32 v105, s46
    v_add_f32 v105, s47, v105
    v_add_f32 v107, v107, v105
    v_mul_f32 v107, s42, v107
    v_cvt_pk_bf16_f32 v104, v106, v107
    v_lshlrev_b32 v106, 16, v104
    v_and_b32 v107, 0xffff0000, v104
    v_add_f32 v107, s43, v107
    v_cvt_pk_bf16_f32 v104, v107, v107
    v_lshlrev_b32 v107, 16, v104
    v_sqrt_f32 v107, v107
    s_nop 0
    v_cvt_pk_bf16_f32 v104, v107, v107
    v_lshlrev_b32 v107, 16, v104
    v_rcp_f32 v107, v107
    v_sub_f32 v48, v40, v106
    v_sub_f32 v49, v41, v106
    v_sub_f32 v50, v42, v106
    v_sub_f32 v51, v43, v106
    v_sub_f32 v52, v44, v106
    v_sub_f32 v53, v45, v106
    v_sub_f32 v54, v46, v106
    v_sub_f32 v55, v47, v106
    v_cvt_pk_bf16_f32 v104, v48, v49
    v_lshlrev_b32 v48, 16, v104
    v_and_b32 v49, 0xffff0000, v104
    v_cvt_pk_bf16_f32 v105, v50, v51
    v_lshlrev_b32 v50, 16, v105
    v_and_b32 v51, 0xffff0000, v105
    v_cvt_pk_bf16_f32 v104, v52, v53
    v_lshlrev_b32 v52, 16, v104
    v_and_b32 v53, 0xffff0000, v104
    v_cvt_pk_bf16_f32 v105, v54, v55
    v_lshlrev_b32 v54, 16, v105
    v_and_b32 v55, 0xffff0000, v105
    v_mul_f32 v48, v48, v107
    v_mul_f32 v49, v49, v107
    v_mul_f32 v50, v50, v107
    v_mul_f32 v51, v51, v107
    v_mul_f32 v52, v52, v107
    v_mul_f32 v53, v53, v107
    v_mul_f32 v54, v54, v107
    v_mul_f32 v55, v55, v107
    v_cvt_pk_bf16_f32 v104, v48, v49
    v_lshlrev_b32 v48, 16, v104
    v_and_b32 v49, 0xffff0000, v104
    v_cvt_pk_bf16_f32 v105, v50, v51
    v_lshlrev_b32 v50, 16, v105
    v_and_b32 v51, 0xffff0000, v105
    v_cvt_pk_bf16_f32 v104, v52, v53
    v_lshlrev_b32 v52, 16, v104
    v_and_b32 v53, 0xffff0000, v104
    v_cvt_pk_bf16_f32 v105, v54, v55
    v_lshlrev_b32 v54, 16, v105
    v_and_b32 v55, 0xffff0000, v105
    v_mul_f32 v48, v48, v72
    v_mul_f32 v49, v49, v73
    v_mul_f32 v50, v50, v74
    v_mul_f32 v51, v51, v75
    v_mul_f32 v52, v52, v76
    v_mul_f32 v53, v53, v77
    v_mul_f32 v54, v54, v78
    v_mul_f32 v55, v55, v79
    v_cvt_pk_bf16_f32 v104, v48, v49
    v_lshlrev_b32 v48, 16, v104
    v_and_b32 v49, 0xffff0000, v104
    v_cvt_pk_bf16_f32 v105, v50, v51
    v_lshlrev_b32 v50, 16, v105
    v_and_b32 v51, 0xffff0000, v105
    v_cvt_pk_bf16_f32 v104, v52, v53
    v_lshlrev_b32 v52, 16, v104
    v_and_b32 v53, 0xffff0000, v104
    v_cvt_pk_bf16_f32 v105, v54, v55
    v_lshlrev_b32 v54, 16, v105
    v_and_b32 v55, 0xffff0000, v105
    v_add_f32 v48, v48, v64
    v_add_f32 v49, v49, v65
    v_add_f32 v50, v50, v66
    v_add_f32 v51, v51, v67
    v_add_f32 v52, v52, v68
    v_add_f32 v53, v53, v69
    v_add_f32 v54, v54, v70
    v_add_f32 v55, v55, v71
    v_cvt_pk_bf16_f32 v104, v48, v49
    v_lshlrev_b32 v48, 16, v104
    v_and_b32 v49, 0xffff0000, v104
    v_cvt_pk_bf16_f32 v105, v50, v51
    v_lshlrev_b32 v50, 16, v105
    v_and_b32 v51, 0xffff0000, v105
    v_cvt_pk_bf16_f32 v104, v52, v53
    v_lshlrev_b32 v52, 16, v104
    v_and_b32 v53, 0xffff0000, v104
    v_cvt_pk_bf16_f32 v105, v54, v55
    v_lshlrev_b32 v54, 16, v105
    v_and_b32 v55, 0xffff0000, v105
    s_cmp_eq_u32 s97, 0
    s_cbranch_scc1 M_NOREP
    s_mov_b32 s40, 0x05040100
    s_mov_b32 s41, 0x07060302
    v_lshlrev_b32 v11, 4, v240
    s_sub_u32 s29, s3, 4
    s_lshl_b32 s29, s29, 14
    s_add_u32 s29, s29, 86016
    s_waitcnt vmcnt(0)
    s_bitcmp1_b32 s97, 0
    s_cbranch_scc0 RPP_10W
    v_and_b32 v241, 31, v240
    v_lshrrev_b32 v242, 5, v240
    v_lshrrev_b32 v7, 1, v241
    v_lshlrev_b32 v7, 10, v7
    v_and_b32 v6, 1, v241
    v_lshl_add_u32 v7, v6, 8, v7
    v_lshl_add_u32 v7, v242, 9, v7
    v_add_u32 v7, s29, v7
    v_and_b32 v8, 7, v241
    v_lshlrev_b32 v8, 4, v8
    v_and_b32 v9, 7, v240
    v_bfe_u32 v10, v240, 4, 1
    v_xor_b32 v9, v9, v10
    v_lshlrev_b32 v9, 4, v9
    v_lshrrev_b32 v10, 3, v240
    v_lshl_add_u32 v9, v10, 7, v9
    v_add_u32 v9, s29, v9
    s_mul_i32 s36, s99, 448
    s_add_u32 s36, s36, s98
    s_lshl_b32 s36, s36, 10
    s_add_u32 s36, s36, 0x800000
    v_perm_b32 v16, v148, v144, s40
    v_perm_b32 v17, v156, v152, s40
    v_perm_b32 v18, v164, v160, s40
    v_perm_b32 v19, v172, v168, s40
    v_xor_b32 v12, 0, v8
    v_add_u32 v12, v12, v7
    ds_write_b128 v12, v[16:19] offset:0
    v_perm_b32 v20, v148, v144, s41
    v_perm_b32 v21, v156, v152, s41
    v_perm_b32 v22, v164, v160, s41
    v_perm_b32 v23, v172, v168, s41
    v_xor_b32 v12, 16, v8
    v_add_u32 v12, v12, v7
    ds_write_b128 v12, v[20:23] offset:0
    v_perm_b32 v24, v149, v145, s40
    v_perm_b32 v25, v157, v153, s40
    v_perm_b32 v26, v165, v161, s40
    v_perm_b32 v27, v173, v169, s40
    v_xor_b32 v12, 32, v8
    v_add_u32 v12, v12, v7
    ds_write_b128 v12, v[24:27] offset:0
    v_perm_b32 v28, v149, v145, s41
    v_perm_b32 v29, v157, v153, s41
    v_perm_b32 v30, v165, v161, s41
    v_perm_b32 v31, v173, v169, s41
    v_xor_b32 v12, 48, v8
    v_add_u32 v12, v12, v7
    ds_write_b128 v12, v[28:31] offset:0
    v_perm_b32 v16, v150, v146, s40
    v_perm_b32 v17, v158, v154, s40
    v_perm_b32 v18, v166, v162, s40
    v_perm_b32 v19, v174, v170, s40
    v_xor_b32 v12, 64, v8
    v_add_u32 v12, v12, v7
    ds_write_b128 v12, v[16:19] offset:0
    v_perm_b32 v20, v150, v146, s41
    v_perm_b32 v21, v158, v154, s41
    v_perm_b32 v22, v166, v162, s41
    v_perm_b32 v23, v174, v170, s41
    v_xor_b32 v12, 80, v8
    v_add_u32 v12, v12, v7
    ds_write_b128 v12, v[20:23] offset:0
    v_perm_b32 v24, v151, v147, s40
    v_perm_b32 v25, v159, v155, s40
    v_perm_b32 v26, v167, v163, s40
    v_perm_b32 v27, v175, v171, s40
    v_xor_b32 v12, 96, v8
    v_add_u32 v12, v12, v7
    ds_write_b128 v12, v[24:27] offset:0
    v_perm_b32 v28, v151, v147, s41
    v_perm_b32 v29, v159, v155, s41
    v_perm_b32 v30, v167, v163, s41
    v_perm_b32 v31, v175, v171, s41
    v_xor_b32 v12, 112, v8
    v_add_u32 v12, v12, v7
    ds_write_b128 v12, v[28:31] offset:0
    v_perm_b32 v16, v180, v176, s40
    v_perm_b32 v17, v188, v184, s40
    v_perm_b32 v18, v196, v192, s40
    v_perm_b32 v19, v204, v200, s40
    v_xor_b32 v12, 0, v8
    v_add_u32 v12, v12, v7
    ds_write_b128 v12, v[16:19] offset:128
    v_perm_b32 v20, v180, v176, s41
    v_perm_b32 v21, v188, v184, s41
    v_perm_b32 v22, v196, v192, s41
    v_perm_b32 v23, v204, v200, s41
    v_xor_b32 v12, 16, v8
    v_add_u32 v12, v12, v7
    ds_write_b128 v12, v[20:23] offset:128
    v_perm_b32 v24, v181, v177, s40
    v_perm_b32 v25, v189, v185, s40
    v_perm_b32 v26, v197, v193, s40
    v_perm_b32 v27, v205, v201, s40
    v_xor_b32 v12, 32, v8
    v_add_u32 v12, v12, v7
    ds_write_b128 v12, v[24:27] offset:128
    v_perm_b32 v28, v181, v177, s41
    v_perm_b32 v29, v189, v185, s41
    v_perm_b32 v30, v197, v193, s41
    v_perm_b32 v31, v205, v201, s41
    v_xor_b32 v12, 48, v8
    v_add_u32 v12, v12, v7
    ds_write_b128 v12, v[28:31] offset:128
    v_perm_b32 v16, v182, v178, s40
    v_perm_b32 v17, v190, v186, s40
    v_perm_b32 v18, v198, v194, s40
    v_perm_b32 v19, v206, v202, s40
    v_xor_b32 v12, 64, v8
    v_add_u32 v12, v12, v7
    ds_write_b128 v12, v[16:19] offset:128
    v_perm_b32 v20, v182, v178, s41
    v_perm_b32 v21, v190, v186, s41
    v_perm_b32 v22, v198, v194, s41
    v_perm_b32 v23, v206, v202, s41
    v_xor_b32 v12, 80, v8
    v_add_u32 v12, v12, v7
    ds_write_b128 v12, v[20:23] offset:128
    v_perm_b32 v24, v183, v179, s40
    v_perm_b32 v25, v191, v187, s40
    v_perm_b32 v26, v199, v195, s40
    v_perm_b32 v27, v207, v203, s40
    v_xor_b32 v12, 96, v8
    v_add_u32 v12, v12, v7
    ds_write_b128 v12, v[24:27] offset:128
    v_perm_b32 v28, v183, v179, s41
    v_perm_b32 v29, v191, v187, s41
    v_perm_b32 v30, v199, v195, s41
    v_perm_b32 v31, v207, v203, s41
    v_xor_b32 v12, 112, v8
    v_add_u32 v12, v12, v7
    ds_write_b128 v12, v[28:31] offset:128
    s_waitcnt lgkmcnt(0)
    v_xor_b32 v12, 0, v9
    v_xor_b32 v13, 32, v9
    v_xor_b32 v14, 64, v9
    v_xor_b32 v15, 96, v9
    ds_read_b128 v[144:147], v12 offset:0
    ds_read_b128 v[148:151], v13 offset:1024
    ds_read_b128 v[152:155], v14 offset:2048
    ds_read_b128 v[156:159], v15 offset:3072
    ds_read_b128 v[160:163], v12 offset:4096
    ds_read_b128 v[164:167], v13 offset:5120
    ds_read_b128 v[168:171], v14 offset:6144
    ds_read_b128 v[172:175], v15 offset:7168
    ds_read_b128 v[176:179], v12 offset:8192
    ds_read_b128 v[180:183], v13 offset:9216
    ds_read_b128 v[184:187], v14 offset:10240
    ds_read_b128 v[188:191], v15 offset:11264
    ds_read_b128 v[192:195], v12 offset:12288
    ds_read_b128 v[196:199], v13 offset:13312
    ds_read_b128 v[200:203], v14 offset:14336
    ds_read_b128 v[204:207], v15 offset:15360
    s_waitcnt lgkmcnt(15)
    buffer_store_dwordx4 v[144:147], v11, s[20:23], s36 offen sc1
    s_add_u32 s36, s36, 28672
    s_waitcnt lgkmcnt(14)
    buffer_store_dwordx4 v[148:151], v11, s[20:23], s36 offen sc1
    s_add_u32 s36, s36, 28672
    s_waitcnt lgkmcnt(13)
    buffer_store_dwordx4 v[152:155], v11, s[20:23], s36 offen sc1
    s_add_u32 s36, s36, 28672
    s_waitcnt lgkmcnt(12)
    buffer_store_dwordx4 v[156:159], v11, s[20:23], s36 offen sc1
    s_add_u32 s36, s36, 28672
    s_waitcnt lgkmcnt(11)
    buffer_store_dwordx4 v[160:163], v11, s[20:23], s36 offen sc1
    s_add_u32 s36, s36, 28672
    s_waitcnt lgkmcnt(10)
    buffer_store_dwordx4 v[164:167], v11, s[20:23], s36 offen sc1
    s_add_u32 s36, s36, 28672
    s_waitcnt lgkmcnt(9)
    buffer_store_dwordx4 v[168:171], v11, s[20:23], s36 offen sc1
    s_add_u32 s36, s36, 28672
    s_waitcnt lgkmcnt(8)
    buffer_store_dwordx4 v[172:175], v11, s[20:23], s36 offen sc1
    s_add_u32 s36, s36, 28672
    s_waitcnt lgkmcnt(7)
    buffer_store_dwordx4 v[176:179], v11, s[20:23], s36 offen sc1
    s_add_u32 s36, s36, 28672
    s_waitcnt lgkmcnt(6)
    buffer_store_dwordx4 v[180:183], v11, s[20:23], s36 offen sc1
    s_add_u32 s36, s36, 28672
    s_waitcnt lgkmcnt(5)
    buffer_store_dwordx4 v[184:187], v11, s[20:23], s36 offen sc1
    s_add_u32 s36, s36, 28672
    s_waitcnt lgkmcnt(4)
    buffer_store_dwordx4 v[188:191], v11, s[20:23], s36 offen sc1
    s_add_u32 s36, s36, 28672
    s_waitcnt lgkmcnt(3)
    buffer_store_dwordx4 v[192:195], v11, s[20:23], s36 offen sc1
    s_add_u32 s36, s36, 28672
    s_waitcnt lgkmcnt(2)
    buffer_store_dwordx4 v[196:199], v11, s[20:23], s36 offen sc1
    s_add_u32 s36, s36, 28672
    s_waitcnt lgkmcnt(1)
    buffer_store_dwordx4 v[200:203], v11, s[20:23], s36 offen sc1
    s_add_u32 s36, s36, 28672
    s_waitcnt lgkmcnt(0)
    buffer_store_dwordx4 v[204:207], v11, s[20:23], s36 offen sc1
    s_add_u32 s36, s36, 28672
RPP_10W:
    s_bitcmp1_b32 s97, 1
    s_cbranch_scc0 RPP_10E
    v_and_b32 v241, 7, v240
    v_lshrrev_b32 v242, 3, v240
    v_lshrrev_b32 v7, 2, v241
    v_lshlrev_b32 v7, 12, v7
    v_lshl_add_u32 v7, v242, 9, v7
    v_and_b32 v6, 3, v241
    v_lshl_add_u32 v7, v6, 7, v7
    v_add_u32 v7, s29, v7
    v_lshlrev_b32 v8, 4, v241
    v_and_b32 v9, 7, v240
    v_bfe_u32 v10, v240, 3, 2
    v_xor_b32 v9, v9, v10
    v_lshlrev_b32 v9, 4, v9
    v_lshrrev_b32 v10, 3, v240
    v_lshl_add_u32 v9, v10, 7, v9
    v_add_u32 v9, s29, v9
    v_xor_b32 v13, 64, v9
    s_mul_i32 s36, s101, 224
    s_lshl_b32 s37, s100, 2
    s_add_u32 s36, s36, s37
    s_lshl_b32 s36, s36, 10
    s_add_u32 s36, s36, 0xc00000
    v_perm_b32 v16, v212, v208, s40
    v_perm_b32 v17, v220, v216, s40
    v_perm_b32 v18, v228, v224, s40
    v_perm_b32 v19, v236, v232, s40
    v_xor_b32 v12, 0, v8
    v_add_u32 v12, v12, v7
    ds_write_b128 v12, v[16:19]
    v_perm_b32 v20, v212, v208, s41
    v_perm_b32 v21, v220, v216, s41
    v_perm_b32 v22, v228, v224, s41
    v_perm_b32 v23, v236, v232, s41
    v_xor_b32 v12, 16, v8
    v_add_u32 v12, v12, v7
    ds_write_b128 v12, v[20:23]
    v_perm_b32 v24, v213, v209, s40
    v_perm_b32 v25, v221, v217, s40
    v_perm_b32 v26, v229, v225, s40
    v_perm_b32 v27, v237, v233, s40
    v_xor_b32 v12, 32, v8
    v_add_u32 v12, v12, v7
    ds_write_b128 v12, v[24:27]
    v_perm_b32 v28, v213, v209, s41
    v_perm_b32 v29, v221, v217, s41
    v_perm_b32 v30, v229, v225, s41
    v_perm_b32 v31, v237, v233, s41
    v_xor_b32 v12, 48, v8
    v_add_u32 v12, v12, v7
    ds_write_b128 v12, v[28:31]
    v_perm_b32 v16, v214, v210, s40
    v_perm_b32 v17, v222, v218, s40
    v_perm_b32 v18, v230, v226, s40
    v_perm_b32 v19, v238, v234, s40
    v_xor_b32 v12, 64, v8
    v_add_u32 v12, v12, v7
    ds_write_b128 v12, v[16:19]
    v_perm_b32 v20, v214, v210, s41
    v_perm_b32 v21, v222, v218, s41
    v_perm_b32 v22, v230, v226, s41
    v_perm_b32 v23, v238, v234, s41
    v_xor_b32 v12, 80, v8
    v_add_u32 v12, v12, v7
    ds_write_b128 v12, v[20:23]
    v_perm_b32 v24, v215, v211, s40
    v_perm_b32 v25, v223, v219, s40
    v_perm_b32 v26, v231, v227, s40
    v_perm_b32 v27, v239, v235, s40
    v_xor_b32 v12, 96, v8
    v_add_u32 v12, v12, v7
    ds_write_b128 v12, v[24:27]
    v_perm_b32 v28, v215, v211, s41
    v_perm_b32 v29, v223, v219, s41
    v_perm_b32 v30, v231, v227, s41
    v_perm_b32 v31, v239, v235, s41
    v_xor_b32 v12, 112, v8
    v_add_u32 v12, v12, v7
    ds_write_b128 v12, v[28:31]
    s_waitcnt lgkmcnt(0)
    ds_read_b128 v[144:147], v9 offset:0
    ds_read_b128 v[148:151], v9 offset:1024
    ds_read_b128 v[152:155], v9 offset:2048
    ds_read_b128 v[156:159], v9 offset:3072
    ds_read_b128 v[160:163], v13 offset:4096
    ds_read_b128 v[164:167], v13 offset:5120
    ds_read_b128 v[168:171], v13 offset:6144
    ds_read_b128 v[172:175], v13 offset:7168
    s_waitcnt lgkmcnt(7)
    s_add_u32 s37, s36, 0
    buffer_store_dwordx4 v[144:147], v11, s[20:23], s37 offen sc1
    s_waitcnt lgkmcnt(6)
    s_add_u32 s37, s36, 1024
    buffer_store_dwordx4 v[148:151], v11, s[20:23], s37 offen sc1
    s_waitcnt lgkmcnt(5)
    s_add_u32 s37, s36, 2048
    buffer_store_dwordx4 v[152:155], v11, s[20:23], s37 offen sc1
    s_waitcnt lgkmcnt(4)
    s_add_u32 s37, s36, 3072
    buffer_store_dwordx4 v[156:159], v11, s[20:23], s37 offen sc1
    s_waitcnt lgkmcnt(3)
    s_add_u32 s37, s36, 114688
    buffer_store_dwordx4 v[160:163], v11, s[20:23], s37 offen sc1
    s_waitcnt lgkmcnt(2)
    s_add_u32 s37, s36, 115712
    buffer_store_dwordx4 v[164:167], v11, s[20:23], s37 offen sc1
    s_waitcnt lgkmcnt(1)
    s_add_u32 s37, s36, 116736
    buffer_store_dwordx4 v[168:171], v11, s[20:23], s37 offen sc1
    s_waitcnt lgkmcnt(0)
    s_add_u32 s37, s36, 117760
    buffer_store_dwordx4 v[172:175], v11, s[20:23], s37 offen sc1
RPP_10E:
    v_cmp_gt_u32 s[40:41], 56, v126
M_NOREP:
    s_and_b32 s59, s2, 31
    s_lshl_b32 s59, s59, 7
    s_add_u32 s59, s59, 0xa000
    s_cmp_lg_u32 s3, 7
    s_cbranch_scc1 WT_11
    v_and_b32 v1, 63, v0
    v_lshlrev_b32 v1, 2, v1
    s_mov_b64 exec, 0xff
    s_mov_b32 s60, 200000
    buffer_load_dword v4, v1, s[20:23], s59 offen sc1
    s_sleep 3
WT_11P:
    buffer_load_dword v5, v1, s[20:23], s59 offen sc1
    s_waitcnt vmcnt(1)
    v_cmp_eq_u32 vcc, 0, v4
    s_cbranch_vccz WT_11D
    s_sleep 3
    buffer_load_dword v4, v1, s[20:23], s59 offen sc1
    s_waitcnt vmcnt(1)
    v_cmp_eq_u32 vcc, 0, v5
    s_cbranch_vccz WT_11D
    s_sleep 3
    s_sub_u32 s60, s60, 1
    s_cmp_lg_u32 s60, 0
    s_cbranch_scc1 WT_11P
WT_11D:
    s_waitcnt vmcnt(0)
    s_mov_b64 exec, -1
WT_11:
    s_barrier
    v_cmp_gt_u32 vcc, 448, v0
    s_and_saveexec_b64 s[36:37], vcc
    buffer_load_dwordx4 v[8:11], v122, s[20:23], s48 offen sc1
    s_waitcnt vmcnt(0)
    ds_write_b128 v121, v[8:11]
    s_mov_b64 exec, s[36:37]
    s_cmp_eq_u32 s97, 0
    s_cbranch_scc1 LN_NOCHA
    s_and_b32 s59, s2, 7
    s_lshl_b32 s59, s59, 7
    s_add_u32 s59, s59, 0x8480
    v_mov_b32 v1, 0
    v_mov_b32 v20, 1
    s_mov_b64 exec, 1
    buffer_atomic_add v20, v1, s[20:23], s59 offen sc0 sc1
    s_mov_b64 exec, -1
LN_NOCHA:
    s_waitcnt lgkmcnt(0)
    s_barrier
    s_mov_b64 exec, s[40:41]
    ds_read_u16_d16_hi v56, v120 offset:0
    ds_read_u16_d16_hi v57, v120 offset:16
    ds_read_u16_d16_hi v58, v120 offset:32
    ds_read_u16_d16_hi v59, v120 offset:48
    ds_read_u16_d16_hi v60, v120 offset:64
    ds_read_u16_d16_hi v61, v120 offset:80
    ds_read_u16_d16_hi v62, v120 offset:96
    ds_read_u16_d16_hi v63, v120 offset:112
    s_mov_b64 exec, -1
    s_waitcnt lgkmcnt(0)
    v_mul_f32 v48, v48, v56
    v_mul_f32 v49, v49, v57
    v_mul_f32 v50, v50, v58
    v_mul_f32 v51, v51, v59
    v_mul_f32 v52, v52, v60
    v_mul_f32 v53, v53, v61
    v_mul_f32 v54, v54, v62
    v_mul_f32 v55, v55, v63
    v_cvt_pk_bf16_f32 v104, v48, v49
    v_lshlrev_b32 v48, 16, v104
    v_and_b32 v49, 0xffff0000, v104
    v_cvt_pk_bf16_f32 v105, v50, v51
    v_lshlrev_b32 v50, 16, v105
    v_and_b32 v51, 0xffff0000, v105
    v_cvt_pk_bf16_f32 v104, v52, v53
    v_lshlrev_b32 v52, 16, v104
    v_and_b32 v53, 0xffff0000, v104
    v_cvt_pk_bf16_f32 v105, v54, v55
    v_lshlrev_b32 v54, 16, v105
    v_and_b32 v55, 0xffff0000, v105
    v_mul_f32 v48, v48, v80
    v_mul_f32 v49, v49, v81
    v_mul_f32 v50, v50, v82
    v_mul_f32 v51, v51, v83
    v_mul_f32 v52, v52, v84
    v_mul_f32 v53, v53, v85
    v_mul_f32 v54, v54, v86
    v_mul_f32 v55, v55, v87
    v_cvt_pk_bf16_f32 v104, v48, v49
    v_lshlrev_b32 v48, 16, v104
    v_and_b32 v49, 0xffff0000, v104
    v_cvt_pk_bf16_f32 v105, v50, v51
    v_lshlrev_b32 v50, 16, v105
    v_and_b32 v51, 0xffff0000, v105
    v_cvt_pk_bf16_f32 v104, v52, v53
    v_lshlrev_b32 v52, 16, v104
    v_and_b32 v53, 0xffff0000, v104
    v_cvt_pk_bf16_f32 v105, v54, v55
    v_lshlrev_b32 v54, 16, v105
    v_and_b32 v55, 0xffff0000, v105
    v_add_f32 v40, v40, v48
    v_add_f32 v41, v41, v49
    v_add_f32 v42, v42, v50
    v_add_f32 v43, v43, v51
    v_add_f32 v44, v44, v52
    v_add_f32 v45, v45, v53
    v_add_f32 v46, v46, v54
    v_add_f32 v47, v47, v55
    v_cvt_pk_bf16_f32 v12, v40, v41
    v_cvt_pk_bf16_f32 v13, v42, v43
    v_cvt_pk_bf16_f32 v14, v44, v45
    v_cvt_pk_bf16_f32 v15, v46, v47
    v_lshlrev_b32 v40, 16, v12
    v_and_b32 v41, 0xffff0000, v12
    v_lshlrev_b32 v42, 16, v13
    v_and_b32 v43, 0xffff0000, v13
    v_lshlrev_b32 v44, 16, v14
    v_and_b32 v45, 0xffff0000, v14
    v_lshlrev_b32 v46, 16, v15
    v_and_b32 v47, 0xffff0000, v15
    s_cmp_eq_u32 s97, 0
    s_cbranch_scc1 LN_NOCHB
    s_mov_b64 exec, 1
    s_waitcnt vmcnt(0)
    v_cmp_eq_u32 vcc, 48, v20
    s_cbranch_vccz CB_12X
    v_mov_b32 v21, 0
    v_mov_b32 v22, 1
    s_mov_b32 s61, 0x8880
    buffer_atomic_add v22, v21, s[20:23], s61 offen sc0 sc1
    s_waitcnt vmcnt(0)
    v_cmp_eq_u32 vcc, 7, v22
    s_cbranch_vccz CB_12X
    s_mov_b64 exec, 0xffffffff
    v_and_b32 v21, 63, v0
    v_lshlrev_b32 v21, 7, v21
    v_mov_b32 v22, 1
    s_mov_b32 s61, 0xb000
    buffer_store_dword v22, v21, s[20:23], s61 offen sc1
CB_12X:
    s_mov_b64 exec, -1
LN_NOCHB:
    v_add_u32 v4, 0x400000, v124
    s_mov_b64 exec, s[40:41]
    buffer_store_dwordx4 v[12:15], v4, s[20:23], 0 offen sc1
    s_mov_b64 exec, -1
    v_add_f32 v104, v40, v41
    v_add_f32 v105, v42, v43
    v_add_f32 v106, v44, v45
    v_add_f32 v107, v46, v47
    v_add_f32 v104, v104, v105
    v_add_f32 v106, v106, v107
    v_add_f32 v104, v104, v106
    v_cndmask_b32 v104, 0, v104, s[40:41]
    s_nop 1
    v_add_f32_dpp v105, v104, v104 quad_perm:[1,0,3,2] row_mask:0xf bank_mask:0xf
    s_nop 1
    v_add_f32_dpp v104, v105, v105 quad_perm:[2,3,0,1] row_mask:0xf bank_mask:0xf
    s_nop 1
    v_add_f32_dpp v105, v104, v104 row_half_mirror row_mask:0xf bank_mask:0xf
    s_nop 1
    v_add_f32_dpp v104, v105, v105 row_mirror row_mask:0xf bank_mask:0xf
    s_nop 0
    v_readlane_b32 s44, v104, 0
    v_readlane_b32 s45, v104, 16
    v_readlane_b32 s46, v104, 32
    v_readlane_b32 s47, v104, 48
    s_nop 1
    v_mov_b32 v106, s44
    v_add_f32 v106, s45, v106
    v_mov_b32 v105, s46
    v_add_f32 v105, s47, v105
    v_add_f32 v106, v106, v105
    v_mul_f32 v106, s42, v106
    v_sub_f32 v48, v40, v106
    v_sub_f32 v49, v41, v106
    v_sub_f32 v50, v42, v106
    v_sub_f32 v51, v43, v106
    v_sub_f32 v52, v44, v106
    v_sub_f32 v53, v45, v106
    v_sub_f32 v54, v46, v106
    v_sub_f32 v55, v47, v106
    v_mul_f32 v104, v48, v48
    v_mul_f32 v105, v49, v49
    v_fmac_f32 v104, v50, v50
    v_fmac_f32 v105, v51, v51
    v_fmac_f32 v104, v52, v52
    v_fmac_f32 v105, v53, v53
    v_fmac_f32 v104, v54, v54
    v_fmac_f32 v105, v55, v55
    v_add_f32 v104, v104, v105
    v_cndmask_b32 v104, 0, v104, s[40:41]
    s_nop 1
    v_add_f32_dpp v105, v104, v104 quad_perm:[1,0,3,2] row_mask:0xf bank_mask:0xf
    s_nop 1
    v_add_f32_dpp v104, v105, v105 quad_perm:[2,3,0,1] row_mask:0xf bank_mask:0xf
    s_nop 1
    v_add_f32_dpp v105, v104, v104 row_half_mirror row_mask:0xf bank_mask:0xf
    s_nop 1
    v_add_f32_dpp v104, v105, v105 row_mirror row_mask:0xf bank_mask:0xf
    s_nop 0
    v_readlane_b32 s44, v104, 0
    v_readlane_b32 s45, v104, 16
    v_readlane_b32 s46, v104, 32
    v_readlane_b32 s47, v104, 48
    s_nop 1
    v_mov_b32 v107, s44
    v_add_f32 v107, s45, v107
    v_mov_b32 v105, s46
    v_add_f32 v105, s47, v105
    v_add_f32 v107, v107, v105
    v_mul_f32 v107, s42, v107
    v_cvt_pk_bf16_f32 v104, v106, v107
    v_lshlrev_b32 v106, 16, v104
    v_and_b32 v107, 0xffff0000, v104
    v_add_f32 v107, s43, v107
    v_cvt_pk_bf16_f32 v104, v107, v107
    v_lshlrev_b32 v107, 16, v104
    v_sqrt_f32 v107, v107
    s_nop 0
    v_cvt_pk_bf16_f32 v104, v107, v107
    v_lshlrev_b32 v107, 16, v104
    v_rcp_f32 v107, v107
    v_sub_f32 v48, v40, v106
    v_sub_f32 v49, v41, v106
    v_sub_f32 v50, v42, v106
    v_sub_f32 v51, v43, v106
    v_sub_f32 v52, v44, v106
    v_sub_f32 v53, v45, v106
    v_sub_f32 v54, v46, v106
    v_sub_f32 v55, v47, v106
    v_cvt_pk_bf16_f32 v104, v48, v49
    v_lshlrev_b32 v48, 16, v104
    v_and_b32 v49, 0xffff0000, v104
    v_cvt_pk_bf16_f32 v105, v50, v51
    v_lshlrev_b32 v50, 16, v105
    v_and_b32 v51, 0xffff0000, v105
    v_cvt_pk_bf16_f32 v104, v52, v53
    v_lshlrev_b32 v52, 16, v104
    v_and_b32 v53, 0xffff0000, v104
    v_cvt_pk_bf16_f32 v105, v54, v55
    v_lshlrev_b32 v54, 16, v105
    v_and_b32 v55, 0xffff0000, v105
    v_mul_f32 v48, v48, v107
    v_mul_f32 v49, v49, v107
    v_mul_f32 v50, v50, v107
    v_mul_f32 v51, v51, v107
    v_mul_f32 v52, v52, v107
    v_mul_f32 v53, v53, v107
    v_mul_f32 v54, v54, v107
    v_mul_f32 v55, v55, v107
    v_cvt_pk_bf16_f32 v104, v48, v49
    v_lshlrev_b32 v48, 16, v104
    v_and_b32 v49, 0xffff0000, v104
    v_cvt_pk_bf16_f32 v105, v50, v51
    v_lshlrev_b32 v50, 16, v105
    v_and_b32 v51, 0xffff0000, v105
    v_cvt_pk_bf16_f32 v104, v52, v53
    v_lshlrev_b32 v52, 16, v104
    v_and_b32 v53, 0xffff0000, v104
    v_cvt_pk_bf16_f32 v105, v54, v55
    v_lshlrev_b32 v54, 16, v105
    v_and_b32 v55, 0xffff0000, v105
    v_mul_f32 v48, v48, v96
    v_mul_f32 v49, v49, v97
    v_mul_f32 v50, v50, v98
    v_mul_f32 v51, v51, v99
    v_mul_f32 v52, v52, v100
    v_mul_f32 v53, v53, v101
    v_mul_f32 v54, v54, v102
    v_mul_f32 v55, v55, v103
    v_cvt_pk_bf16_f32 v104, v48, v49
    v_lshlrev_b32 v48, 16, v104
    v_and_b32 v49, 0xffff0000, v104
    v_cvt_pk_bf16_f32 v105, v50, v51
    v_lshlrev_b32 v50, 16, v105
    v_and_b32 v51, 0xffff0000, v105
    v_cvt_pk_bf16_f32 v104, v52, v53
    v_lshlrev_b32 v52, 16, v104
    v_and_b32 v53, 0xffff0000, v104
    v_cvt_pk_bf16_f32 v105, v54, v55
    v_lshlrev_b32 v54, 16, v105
    v_and_b32 v55, 0xffff0000, v105
    v_add_f32 v48, v48, v88
    v_add_f32 v49, v49, v89
    v_add_f32 v50, v50, v90
    v_add_f32 v51, v51, v91
    v_add_f32 v52, v52, v92
    v_add_f32 v53, v53, v93
    v_add_f32 v54, v54, v94
    v_add_f32 v55, v55, v95
    v_cvt_pk_bf16_f32 v16, v48, v49
    v_cvt_pk_bf16_f32 v17, v50, v51
    v_cvt_pk_bf16_f32 v18, v52, v53
    v_cvt_pk_bf16_f32 v19, v54, v55
    v_lshlrev_b32 v5, 7, v126
    v_xor_b32 v7, v125, v126
    v_and_b32 v7, 7, v7
    v_lshl_add_u32 v5, v7, 4, v5
    s_mov_b64 exec, s[40:41]
    ds_write_b128 v5, v[16:19] offset:8192
    s_mov_b64 exec, -1
    v_lshrrev_b32 v5, 3, v0
    v_xor_b32 v7, v5, v0
    v_and_b32 v7, 7, v7
    v_lshlrev_b32 v7, 4, v7
    v_lshl_add_u32 v7, v5, 7, v7
    v_and_b32 v6, 7, v0
    v_lshlrev_b32 v6, 4, v6
    v_lshl_add_u32 v6, v5, 9, v6
    s_lshr_b32 s31, s63, 2
    s_mul_i32 s31, s31, 28672
    s_and_b32 s33, s63, 3
    s_lshl_b32 s33, s33, 7
    s_add_u32 s31, s31, s33
    s_add_u32 s31, s31, 0x600000
    v_cmp_gt_u32 vcc, 448, v0
    s_waitcnt lgkmcnt(0)
    s_barrier
    s_and_saveexec_b64 s[36:37], vcc
    ds_read_b128 v[16:19], v7 offset:8192
    s_waitcnt lgkmcnt(0)
    buffer_store_dwordx4 v[16:19], v6, s[20:23], s31 offen sc1
    s_mov_b64 exec, s[36:37]
    s_lshr_b32 s59, s63, 4
    s_lshl_b32 s59, s59, 7
    s_add_u32 s58, s59, 0xc000
    s_add_u32 s59, s59, 0x8900
    s_waitcnt vmcnt(0)
    s_barrier
    s_cmp_lg_u32 s3, 0
    s_cbranch_scc1 ARR_13B
    v_mov_b32 v1, 0
    v_mov_b32 v2, 1
    s_mov_b64 exec, 1
    buffer_atomic_add v2, v1, s[20:23], s59 offen sc0 sc1
    s_barrier
    s_waitcnt vmcnt(0)
    v_cmp_eq_u32 vcc, 15, v2
    s_cbranch_vccz ARR_13X
    s_mov_b64 exec, 0x1
    v_lshlrev_b32 v1, 7, v0
    v_mov_b32 v2, 1
    buffer_store_dword v2, v1, s[20:23], s58 offen sc1
ARR_13X:
    s_mov_b64 exec, -1
    s_branch ARR_13E
ARR_13B:
    s_barrier
ARR_13E:
    s_cmp_ge_u32 s2, 224
    s_cbranch_scc1 M_END
    s_and_b32 s59, s2, 31
    s_lshl_b32 s59, s59, 7
    s_add_u32 s59, s59, 0xb000
    s_cmp_lg_u32 s3, 7
    s_cbranch_scc1 WT_14
    v_and_b32 v1, 63, v0
    v_lshlrev_b32 v1, 2, v1
    s_mov_b64 exec, 0x1
    s_mov_b32 s60, 200000
    buffer_load_dword v4, v1, s[20:23], s59 offen sc1
    s_sleep 3
WT_14P:
    buffer_load_dword v5, v1, s[20:23], s59 offen sc1
    s_waitcnt vmcnt(1)
    v_cmp_eq_u32 vcc, 0, v4
    s_cbranch_vccz WT_14D
    s_sleep 3
    buffer_load_dword v4, v1, s[20:23], s59 offen sc1
    s_waitcnt vmcnt(1)
    v_cmp_eq_u32 vcc, 0, v5
    s_cbranch_vccz WT_14D
    s_sleep 3
    s_sub_u32 s60, s60, 1
    s_cmp_lg_u32 s60, 0
    s_cbranch_scc1 WT_14P
WT_14D:
    s_waitcnt vmcnt(0)
    s_mov_b64 exec, -1
WT_14:
    s_barrier
    s_lshl_b32 s55, s51, 3
    s_add_u32 s55, s55, s3
    s_mul_i32 s55, s55, 28672
    s_add_u32 s55, s55, 0x800000
    s_add_u32 s56, s55, 0
    buffer_load_dwordx4 v[144:147], v127, s[20:23], s56 offen offset:0 sc1
    s_add_u32 s56, s55, 0
    buffer_load_dwordx4 v[148:151], v127, s[20:23], s56 offen offset:1024 sc1
    s_add_u32 s56, s55, 0
    buffer_load_dwordx4 v[152:155], v127, s[20:23], s56 offen offset:2048 sc1
    s_add_u32 s56, s55, 0
    buffer_load_dwordx4 v[156:159], v127, s[20:23], s56 offen offset:3072 sc1
    s_add_u32 s56, s55, 4096
    buffer_load_dwordx4 v[160:163], v127, s[20:23], s56 offen offset:0 sc1
    s_add_u32 s56, s55, 4096
    buffer_load_dwordx4 v[164:167], v127, s[20:23], s56 offen offset:1024 sc1
    s_add_u32 s56, s55, 4096
    buffer_load_dwordx4 v[168:171], v127, s[20:23], s56 offen offset:2048 sc1
    s_add_u32 s56, s55, 4096
    buffer_load_dwordx4 v[172:175], v127, s[20:23], s56 offen offset:3072 sc1
    s_add_u32 s56, s55, 8192
    buffer_load_dwordx4 v[176:179], v127, s[20:23], s56 offen offset:0 sc1
    s_add_u32 s56, s55, 8192
    buffer_load_dwordx4 v[180:183], v127, s[20:23], s56 offen offset:1024 sc1
    s_lshl_b32 s59, s50, 7
    s_add_u32 s59, s59, 0xc000
    s_cmp_lg_u32 s3, 7
    s_cbranch_scc1 WT_15
    v_and_b32 v1, 63, v0
    v_lshlrev_b32 v1, 2, v1
    s_mov_b64 exec, 0x1
    s_mov_b32 s60, 200000
    buffer_load_dword v4, v1, s[20:23], s59 offen sc1
    s_sleep 3
WT_15P:
    buffer_load_dword v5, v1, s[20:23], s59 offen sc1
    s_waitcnt vmcnt(1)
    v_cmp_eq_u32 vcc, 0, v4
    s_cbranch_vccz WT_15D
    s_sleep 3
    buffer_load_dword v4, v1, s[20:23], s59 offen sc1
    s_waitcnt vmcnt(1)
    v_cmp_eq_u32 vcc, 0, v5
    s_cbranch_vccz WT_15D
    s_sleep 3
    s_sub_u32 s60, s60, 1
    s_cmp_lg_u32 s60, 0
    s_cbranch_scc1 WT_15P
WT_15D:
    s_waitcnt vmcnt(0)
    s_mov_b64 exec, -1
WT_15:
    s_barrier
    v_lshlrev_b32 v2, 4, v0
    s_mul_i32 s33, s50, 114688
    s_add_u32 s33, s33, 0x600000
    s_add_u32 s35, s33, 0
    buffer_load_dwordx4 v[96:99], v2, s[20:23], s35 offen sc1
    s_add_u32 s35, s33, 8192
    buffer_load_dwordx4 v[100:103], v2, s[20:23], s35 offen sc1
    s_add_u32 s35, s33, 16384
    buffer_load_dwordx4 v[104:107], v2, s[20:23], s35 offen sc1
    s_add_u32 s35, s33, 24576
    buffer_load_dwordx4 v[108:111], v2, s[20:23], s35 offen sc1
    s_add_u32 s35, s33, 32768
    buffer_load_dwordx4 v[112:115], v2, s[20:23], s35 offen sc1
    s_add_u32 s35, s33, 40960
    buffer_load_dwordx4 v[116:119], v2, s[20:23], s35 offen sc1
    s_add_u32 s35, s33, 49152
    buffer_load_dwordx4 v[120:123], v2, s[20:23], s35 offen sc1
    s_add_u32 s56, s55, 8192
    buffer_load_dwordx4 v[184:187], v127, s[20:23], s56 offen offset:2048 sc1
    s_add_u32 s56, s55, 8192
    buffer_load_dwordx4 v[188:191], v127, s[20:23], s56 offen offset:3072 sc1
    s_add_u32 s56, s55, 12288
    buffer_load_dwordx4 v[192:195], v127, s[20:23], s56 offen offset:0 sc1
    s_add_u32 s56, s55, 12288
    buffer_load_dwordx4 v[196:199], v127, s[20:23], s56 offen offset:1024 sc1
    v_add_u32 v3, 57344, v2
    v_mov_b32 v124, 0xc0135761
    v_mov_b32 v125, 0xbdd2d3e8
    v_add_u32 v4, 57344, v127
    s_lshl_b32 s34, s51, 3
    s_add_u32 s34, s34, s3
    s_mul_i32 s35, s50, 448
    s_add_u32 s34, s34, s35
    s_lshl_b32 s34, s34, 10
    s_add_u32 s34, s34, 0x1000000
    s_waitcnt vmcnt(4)
    ds_write_b128 v2, v[96:99] offset:0
    ds_write_b128 v2, v[100:103] offset:8192
    ds_write_b128 v2, v[104:107] offset:16384
    ds_write_b128 v2, v[108:111] offset:24576
    ds_write_b128 v2, v[112:115] offset:32768
    ds_write_b128 v2, v[116:119] offset:40960
    ds_write_b128 v2, v[120:123] offset:49152
    s_waitcnt lgkmcnt(0)
    s_barrier
    ds_read_b128 v[80:83], v127 offset:0
    ds_read_b128 v[84:87], v127 offset:28672
    ds_read_b128 v[88:91], v127 offset:1024
    ds_read_b128 v[92:95], v127 offset:29696
    s_waitcnt lgkmcnt(3)
    v_mfma_f32_32x32x16_bf16 v[16:31], v[144:147], v[80:83], 0
    s_add_u32 s56, s55, 12288
    buffer_load_dwordx4 v[200:203], v127, s[20:23], s56 offen offset:2048 sc1
    ds_read_b128 v[80:83], v127 offset:2048
    s_waitcnt lgkmcnt(3)
    v_mfma_f32_32x32x16_bf16 v[32:47], v[144:147], v[84:87], 0
    ds_read_b128 v[84:87], v127 offset:30720
    s_waitcnt lgkmcnt(3)
    v_mfma_f32_32x32x16_bf16 v[16:31], v[148:151], v[88:91], v[16:31]
    s_add_u32 s56, s55, 12288
    buffer_load_dwordx4 v[204:207], v127, s[20:23], s56 offen offset:3072 sc1
    ds_read_b128 v[88:91], v127 offset:3072
    s_waitcnt lgkmcnt(3)
    v_mfma_f32_32x32x16_bf16 v[32:47], v[148:151], v[92:95], v[32:47]
    ds_read_b128 v[92:95], v127 offset:31744
    s_waitcnt lgkmcnt(3)
    v_mfma_f32_32x32x16_bf16 v[16:31], v[152:155], v[80:83], v[16:31]
    s_add_u32 s56, s55, 16384
    buffer_load_dwordx4 v[208:211], v127, s[20:23], s56 offen offset:0 sc1
    ds_read_b128 v[80:83], v127 offset:4096
    s_waitcnt lgkmcnt(3)
    v_mfma_f32_32x32x16_bf16 v[32:47], v[152:155], v[84:87], v[32:47]
    s_add_u32 s35, s33, 57344
    buffer_load_dwordx4 v[96:99], v2, s[20:23], s35 offen sc1
    ds_read_b128 v[84:87], v127 offset:32768
    s_waitcnt lgkmcnt(3)
    v_mfma_f32_32x32x16_bf16 v[16:31], v[156:159], v[88:91], v[16:31]
    s_add_u32 s56, s55, 16384
    buffer_load_dwordx4 v[212:215], v127, s[20:23], s56 offen offset:1024 sc1
    ds_read_b128 v[88:91], v127 offset:5120
    s_waitcnt lgkmcnt(3)
    v_mfma_f32_32x32x16_bf16 v[32:47], v[156:159], v[92:95], v[32:47]
    s_add_u32 s35, s33, 65536
    buffer_load_dwordx4 v[100:103], v2, s[20:23], s35 offen sc1
    ds_read_b128 v[92:95], v127 offset:33792
    s_waitcnt lgkmcnt(3)
    v_mfma_f32_32x32x16_bf16 v[16:31], v[160:163], v[80:83], v[16:31]
    s_add_u32 s56, s55, 16384
    buffer_load_dwordx4 v[216:219], v127, s[20:23], s56 offen offset:2048 sc1
    ds_read_b128 v[80:83], v127 offset:6144
    s_waitcnt lgkmcnt(3)
    v_mfma_f32_32x32x16_bf16 v[32:47], v[160:163], v[84:87], v[32:47]
    s_add_u32 s35, s33, 73728
    buffer_load_dwordx4 v[104:107], v2, s[20:23], s35 offen sc1
    ds_read_b128 v[84:87], v127 offset:34816
    s_waitcnt lgkmcnt(3)
    v_mfma_f32_32x32x16_bf16 v[16:31], v[164:167], v[88:91], v[16:31]
    s_add_u32 s56, s55, 16384
    buffer_load_dwordx4 v[220:223], v127, s[20:23], s56 offen offset:3072 sc1
    ds_read_b128 v[88:91], v127 offset:7168
    s_waitcnt lgkmcnt(3)
    v_mfma_f32_32x32x16_bf16 v[32:47], v[164:167], v[92:95], v[32:47]
    s_add_u32 s35, s33, 81920
    buffer_load_dwordx4 v[108:111], v2, s[20:23], s35 offen sc1
    ds_read_b128 v[92:95], v127 offset:35840
    s_waitcnt lgkmcnt(3)
    v_mfma_f32_32x32x16_bf16 v[16:31], v[168:171], v[80:83], v[16:31]
    s_add_u32 s56, s55, 20480
    buffer_load_dwordx4 v[224:227], v127, s[20:23], s56 offen offset:0 sc1
    ds_read_b128 v[80:83], v127 offset:8192
    s_waitcnt lgkmcnt(3)
    v_mfma_f32_32x32x16_bf16 v[32:47], v[168:171], v[84:87], v[32:47]
    s_add_u32 s35, s33, 90112
    buffer_load_dwordx4 v[112:115], v2, s[20:23], s35 offen sc1
    ds_read_b128 v[84:87], v127 offset:36864
    s_waitcnt lgkmcnt(3)
    v_mfma_f32_32x32x16_bf16 v[16:31], v[172:175], v[88:91], v[16:31]
    s_add_u32 s56, s55, 20480
    buffer_load_dwordx4 v[228:231], v127, s[20:23], s56 offen offset:1024 sc1
    ds_read_b128 v[88:91], v127 offset:9216
    s_waitcnt lgkmcnt(3)
    v_mfma_f32_32x32x16_bf16 v[32:47], v[172:175], v[92:95], v[32:47]
    s_add_u32 s35, s33, 98304
    buffer_load_dwordx4 v[116:119], v2, s[20:23], s35 offen sc1
    ds_read_b128 v[92:95], v127 offset:37888
    s_waitcnt lgkmcnt(3)
    v_mfma_f32_32x32x16_bf16 v[16:31], v[176:179], v[80:83], v[16:31]
    s_add_u32 s56, s55, 20480
    buffer_load_dwordx4 v[232:235], v127, s[20:23], s56 offen offset:2048 sc1
    ds_read_b128 v[80:83], v127 offset:10240
    s_waitcnt lgkmcnt(3)
    v_mfma_f32_32x32x16_bf16 v[32:47], v[176:179], v[84:87], v[32:47]
    s_add_u32 s35, s33, 106496
    buffer_load_dwordx4 v[120:123], v2, s[20:23], s35 offen sc1
    ds_read_b128 v[84:87], v127 offset:38912
    s_waitcnt lgkmcnt(3)
    v_mfma_f32_32x32x16_bf16 v[16:31], v[180:183], v[88:91], v[16:31]
    s_add_u32 s56, s55, 20480
    buffer_load_dwordx4 v[236:239], v127, s[20:23], s56 offen offset:3072 sc1
    ds_read_b128 v[88:91], v127 offset:11264
    s_waitcnt lgkmcnt(3)
    v_mfma_f32_32x32x16_bf16 v[32:47], v[180:183], v[92:95], v[32:47]
    ds_read_b128 v[92:95], v127 offset:39936
    s_waitcnt lgkmcnt(3)
    s_waitcnt vmcnt(20)
    v_mfma_f32_32x32x16_bf16 v[16:31], v[184:187], v[80:83], v[16:31]
    s_add_u32 s56, s55, 24576
    buffer_load_dwordx4 v[240:243], v127, s[20:23], s56 offen offset:0 sc1
    ds_read_b128 v[80:83], v127 offset:12288
    s_waitcnt lgkmcnt(3)
    v_mfma_f32_32x32x16_bf16 v[32:47], v[184:187], v[84:87], v[32:47]
    ds_read_b128 v[84:87], v127 offset:40960
    s_waitcnt lgkmcnt(3)
    s_waitcnt vmcnt(20)
    v_mfma_f32_32x32x16_bf16 v[16:31], v[188:191], v[88:91], v[16:31]
    s_add_u32 s56, s55, 24576
    buffer_load_dwordx4 v[244:247], v127, s[20:23], s56 offen offset:1024 sc1
    ds_read_b128 v[88:91], v127 offset:13312
    s_waitcnt lgkmcnt(3)
    v_mfma_f32_32x32x16_bf16 v[32:47], v[188:191], v[92:95], v[32:47]
    ds_read_b128 v[92:95], v127 offset:41984
    s_waitcnt lgkmcnt(3)
    s_waitcnt vmcnt(20)
    v_mfma_f32_32x32x16_bf16 v[16:31], v[192:195], v[80:83], v[16:31]
    s_add_u32 s56, s55, 24576
    buffer_load_dwordx4 v[248:251], v127, s[20:23], s56 offen offset:2048 sc1
    ds_read_b128 v[80:83], v127 offset:14336
    s_waitcnt lgkmcnt(3)
    v_mfma_f32_32x32x16_bf16 v[32:47], v[192:195], v[84:87], v[32:47]
    ds_read_b128 v[84:87], v127 offset:43008
    s_waitcnt lgkmcnt(3)
    s_waitcnt vmcnt(20)
    v_mfma_f32_32x32x16_bf16 v[16:31], v[196:199], v[88:91], v[16:31]
    s_add_u32 s56, s55, 24576
    buffer_load_dwordx4 v[252:255], v127, s[20:23], s56 offen offset:3072 sc1
    ds_read_b128 v[88:91], v127 offset:15360
    s_waitcnt lgkmcnt(3)
    v_mfma_f32_32x32x16_bf16 v[32:47], v[196:199], v[92:95], v[32:47]
    ds_read_b128 v[92:95], v127 offset:44032
    s_waitcnt lgkmcnt(3)
    s_waitcnt vmcnt(20)
    v_mfma_f32_32x32x16_bf16 v[16:31], v[200:203], v[80:83], v[16:31]
    ds_read_b128 v[80:83], v127 offset:16384
    s_waitcnt lgkmcnt(3)
    v_mfma_f32_32x32x16_bf16 v[32:47], v[200:203], v[84:87], v[32:47]
    ds_read_b128 v[84:87], v127 offset:45056
    s_waitcnt lgkmcnt(3)
    s_waitcnt vmcnt(19)
    v_mfma_f32_32x32x16_bf16 v[16:31], v[204:207], v[88:91], v[16:31]
    ds_read_b128 v[88:91], v127 offset:17408
    s_waitcnt lgkmcnt(3)
    v_mfma_f32_32x32x16_bf16 v[32:47], v[204:207], v[92:95], v[32:47]
    ds_read_b128 v[92:95], v127 offset:46080
    s_waitcnt lgkmcnt(3)
    s_waitcnt vmcnt(18)
    v_mfma_f32_32x32x16_bf16 v[16:31], v[208:211], v[80:83], v[16:31]
    ds_read_b128 v[80:83], v127 offset:18432
    s_waitcnt lgkmcnt(3)
    v_mfma_f32_32x32x16_bf16 v[32:47], v[208:211], v[84:87], v[32:47]
    ds_read_b128 v[84:87], v127 offset:47104
    s_waitcnt lgkmcnt(3)
    s_waitcnt vmcnt(16)
    v_mfma_f32_32x32x16_bf16 v[16:31], v[212:215], v[88:91], v[16:31]
    ds_read_b128 v[88:91], v127 offset:19456
    s_waitcnt lgkmcnt(3)
    v_mfma_f32_32x32x16_bf16 v[32:47], v[212:215], v[92:95], v[32:47]
    ds_read_b128 v[92:95], v127 offset:48128
    s_waitcnt lgkmcnt(3)
    s_waitcnt vmcnt(14)
    v_mfma_f32_32x32x16_bf16 v[16:31], v[216:219], v[80:83], v[16:31]
    ds_read_b128 v[80:83], v127 offset:20480
    s_waitcnt lgkmcnt(3)
    v_mfma_f32_32x32x16_bf16 v[32:47], v[216:219], v[84:87], v[32:47]
    ds_read_b128 v[84:87], v127 offset:49152
    s_waitcnt lgkmcnt(3)
    s_waitcnt vmcnt(12)
    v_mfma_f32_32x32x16_bf16 v[16:31], v[220:223], v[88:91], v[16:31]
    ds_read_b128 v[88:91], v127 offset:21504
    s_waitcnt lgkmcnt(3)
    v_mfma_f32_32x32x16_bf16 v[32:47], v[220:223], v[92:95], v[32:47]
    ds_read_b128 v[92:95], v127 offset:50176
    s_waitcnt lgkmcnt(3)
    s_waitcnt vmcnt(10)
    v_mfma_f32_32x32x16_bf16 v[16:31], v[224:227], v[80:83], v[16:31]
    ds_read_b128 v[80:83], v127 offset:22528
    s_waitcnt lgkmcnt(3)
    v_mfma_f32_32x32x16_bf16 v[32:47], v[224:227], v[84:87], v[32:47]
    ds_read_b128 v[84:87], v127 offset:51200
    s_waitcnt lgkmcnt(3)
    s_waitcnt vmcnt(8)
    v_mfma_f32_32x32x16_bf16 v[16:31], v[228:231], v[88:91], v[16:31]
    ds_read_b128 v[88:91], v127 offset:23552
    s_waitcnt lgkmcnt(3)
    v_mfma_f32_32x32x16_bf16 v[32:47], v[228:231], v[92:95], v[32:47]
    ds_read_b128 v[92:95], v127 offset:52224
    s_waitcnt lgkmcnt(3)
    s_waitcnt vmcnt(6)
    v_mfma_f32_32x32x16_bf16 v[16:31], v[232:235], v[80:83], v[16:31]
    ds_read_b128 v[80:83], v127 offset:24576
    s_waitcnt lgkmcnt(3)
    v_mfma_f32_32x32x16_bf16 v[32:47], v[232:235], v[84:87], v[32:47]
    ds_read_b128 v[84:87], v127 offset:53248
    s_waitcnt lgkmcnt(3)
    s_waitcnt vmcnt(4)
    v_mfma_f32_32x32x16_bf16 v[16:31], v[236:239], v[88:91], v[16:31]
    ds_read_b128 v[88:91], v127 offset:25600
    s_waitcnt lgkmcnt(3)
    v_mfma_f32_32x32x16_bf16 v[32:47], v[236:239], v[92:95], v[32:47]
    ds_read_b128 v[92:95], v127 offset:54272
    s_waitcnt lgkmcnt(3)
    s_waitcnt vmcnt(3)
    v_mfma_f32_32x32x16_bf16 v[16:31], v[240:243], v[80:83], v[16:31]
    ds_read_b128 v[80:83], v127 offset:26624
    s_waitcnt lgkmcnt(3)
    v_mfma_f32_32x32x16_bf16 v[32:47], v[240:243], v[84:87], v[32:47]
    ds_read_b128 v[84:87], v127 offset:55296
    s_waitcnt lgkmcnt(3)
    s_waitcnt vmcnt(2)
    v_mfma_f32_32x32x16_bf16 v[16:31], v[244:247], v[88:91], v[16:31]
    ds_read_b128 v[88:91], v127 offset:27648
    s_waitcnt lgkmcnt(3)
    v_mfma_f32_32x32x16_bf16 v[32:47], v[244:247], v[92:95], v[32:47]
    ds_read_b128 v[92:95], v127 offset:56320
    s_waitcnt lgkmcnt(3)
    s_waitcnt vmcnt(1)
    v_mfma_f32_32x32x16_bf16 v[16:31], v[248:251], v[80:83], v[16:31]
    s_waitcnt vmcnt(5)
    ds_write_b128 v3, v[96:99] offset:0
    ds_write_b128 v3, v[100:103] offset:8192
    ds_write_b128 v3, v[104:107] offset:16384
    ds_write_b128 v3, v[108:111] offset:24576
    ds_write_b128 v3, v[112:115] offset:32768
    ds_write_b128 v3, v[116:119] offset:40960
    ds_write_b128 v3, v[120:123] offset:49152
    s_waitcnt lgkmcnt(0)
    s_barrier
    s_and_b32 s54, s2, 7
    s_lshr_b32 s57, s2, 3
    s_lshl_b32 s52, s54, 2
    s_and_b32 s56, s57, 3
    s_add_u32 s52, s52, s56
    s_lshr_b32 s53, s57, 2
    s_mul_i32 s56, s53, 229376
    s_mul_i32 s57, s3, 14336
    s_add_u32 s56, s56, s57
    s_add_u32 s56, s56, 0xc00000
    ds_read_b128 v[80:83], v4 offset:0
    s_waitcnt lgkmcnt(3)
    v_mfma_f32_32x32x16_bf16 v[32:47], v[248:251], v[84:87], v[32:47]
    ds_read_b128 v[84:87], v4 offset:28672
    s_waitcnt lgkmcnt(3)
    s_waitcnt vmcnt(0)
    v_mfma_f32_32x32x16_bf16 v[16:31], v[252:255], v[88:91], v[16:31]
    ds_read_b128 v[88:91], v4 offset:1024
    s_waitcnt lgkmcnt(3)
    v_mfma_f32_32x32x16_bf16 v[32:47], v[252:255], v[92:95], v[32:47]
    ds_read_b128 v[92:95], v4 offset:29696
    s_waitcnt lgkmcnt(3)
    v_mfma_f32_32x32x16_bf16 v[48:63], v[144:147], v[80:83], 0
    ds_read_b128 v[80:83], v4 offset:2048
    s_waitcnt lgkmcnt(3)
    v_mfma_f32_32x32x16_bf16 v[64:79], v[144:147], v[84:87], 0
    s_add_u32 s58, s56, 0
    buffer_load_dwordx4 v[144:147], v127, s[20:23], s58 offen offset:0 sc1
    ds_read_b128 v[84:87], v4 offset:30720
    s_waitcnt lgkmcnt(3)
    v_mfma_f32_32x32x16_bf16 v[48:63], v[148:151], v[88:91], v[48:63]
    ds_read_b128 v[88:91], v4 offset:3072
    s_waitcnt lgkmcnt(3)
    v_mfma_f32_32x32x16_bf16 v[64:79], v[148:151], v[92:95], v[64:79]
    s_add_u32 s58, s56, 0
    buffer_load_dwordx4 v[148:151], v127, s[20:23], s58 offen offset:1024 sc1
    ds_read_b128 v[92:95], v4 offset:31744
    s_waitcnt lgkmcnt(3)
    v_mfma_f32_32x32x16_bf16 v[48:63], v[152:155], v[80:83], v[48:63]
    ds_read_b128 v[80:83], v4 offset:4096
    s_waitcnt lgkmcnt(3)
    v_mfma_f32_32x32x16_bf16 v[64:79], v[152:155], v[84:87], v[64:79]
    s_add_u32 s58, s56, 0
    buffer_load_dwordx4 v[152:155], v127, s[20:23], s58 offen offset:2048 sc1
    ds_read_b128 v[84:87], v4 offset:32768
    s_waitcnt lgkmcnt(3)
    v_mfma_f32_32x32x16_bf16 v[48:63], v[156:159], v[88:91], v[48:63]
    v_cvt_pk_bf16_f32 v128, v16, v17
    v_lshlrev_b32 v16, 16, v128
    v_and_b32 v17, 0xffff0000, v128
    v_cvt_pk_bf16_f32 v129, v20, v21
    v_lshlrev_b32 v20, 16, v129
    ds_read_b128 v[88:91], v4 offset:5120
    s_waitcnt lgkmcnt(3)
    v_mfma_f32_32x32x16_bf16 v[64:79], v[156:159], v[92:95], v[64:79]
    s_add_u32 s58, s56, 0
    buffer_load_dwordx4 v[156:159], v127, s[20:23], s58 offen offset:3072 sc1
    v_and_b32 v21, 0xffff0000, v129
    v_cvt_pk_bf16_f32 v130, v18, v19
    v_lshlrev_b32 v18, 16, v130
    v_and_b32 v19, 0xffff0000, v130
    v_cvt_pk_bf16_f32 v131, v22, v23
    ds_read_b128 v[92:95], v4 offset:33792
    s_waitcnt lgkmcnt(3)
    v_mfma_f32_32x32x16_bf16 v[48:63], v[160:163], v[80:83], v[48:63]
    v_lshlrev_b32 v22, 16, v131
    v_and_b32 v23, 0xffff0000, v131
    v_cvt_pk_bf16_f32 v132, v24, v25
    v_lshlrev_b32 v24, 16, v132
    v_and_b32 v25, 0xffff0000, v132
    ds_read_b128 v[80:83], v4 offset:6144
    s_waitcnt lgkmcnt(3)
    v_mfma_f32_32x32x16_bf16 v[64:79], v[160:163], v[84:87], v[64:79]
    s_add_u32 s58, s56, 4096
    buffer_load_dwordx4 v[160:163], v127, s[20:23], s58 offen offset:0 sc1
    v_cvt_pk_bf16_f32 v133, v28, v29
    v_lshlrev_b32 v28, 16, v133
    v_and_b32 v29, 0xffff0000, v133
    v_cvt_pk_bf16_f32 v134, v26, v27
    v_lshlrev_b32 v26, 16, v134
    ds_read_b128 v[84:87], v4 offset:34816
    s_waitcnt lgkmcnt(3)
    v_mfma_f32_32x32x16_bf16 v[48:63], v[164:167], v[88:91], v[48:63]
    v_and_b32 v27, 0xffff0000, v134
    v_cvt_pk_bf16_f32 v135, v30, v31
    v_lshlrev_b32 v30, 16, v135
    v_and_b32 v31, 0xffff0000, v135
    v_mul_f32 v128, v16, v16
    ds_read_b128 v[88:91], v4 offset:7168
    s_waitcnt lgkmcnt(3)
    v_mfma_f32_32x32x16_bf16 v[64:79], v[164:167], v[92:95], v[64:79]
    s_add_u32 s58, s56, 4096
    buffer_load_dwordx4 v[164:167], v127, s[20:23], s58 offen offset:1024 sc1
    v_mul_f32 v129, v17, v17
    v_mul_f32 v130, v18, v18
    v_mul_f32 v131, v19, v19
    v_mul_f32 v132, v24, v24
    v_mul_f32 v133, v25, v25
    ds_read_b128 v[92:95], v4 offset:35840
    s_waitcnt lgkmcnt(3)
    v_mfma_f32_32x32x16_bf16 v[48:63], v[168:171], v[80:83], v[48:63]
    v_mul_f32 v134, v26, v26
    v_mul_f32 v135, v27, v27
    v_fma_f32 v128, v128, v125, v124
    v_fma_f32 v129, v129, v125, v124
    v_fma_f32 v130, v130, v125, v124
    ds_read_b128 v[80:83], v4 offset:8192
    s_waitcnt lgkmcnt(3)
    v_mfma_f32_32x32x16_bf16 v[64:79], v[168:171], v[84:87], v[64:79]
    s_add_u32 s58, s56, 4096
    buffer_load_dwordx4 v[168:171], v127, s[20:23], s58 offen offset:2048 sc1
    v_fma_f32 v131, v131, v125, v124
    v_fma_f32 v132, v132, v125, v124
    v_fma_f32 v133, v133, v125, v124
    v_fma_f32 v134, v134, v125, v124
    v_fma_f32 v135, v135, v125, v124
    ds_read_b128 v[84:87], v4 offset:36864
    s_waitcnt lgkmcnt(3)
    v_mfma_f32_32x32x16_bf16 v[48:63], v[172:175], v[88:91], v[48:63]
    v_mul_f32 v128, v128, v16
    v_mul_f32 v129, v129, v17
    v_mul_f32 v130, v130, v18
    v_mul_f32 v131, v131, v19
    v_mul_f32 v132, v132, v24
    ds_read_b128 v[88:91], v4 offset:9216
    s_waitcnt lgkmcnt(3)
    v_mfma_f32_32x32x16_bf16 v[64:79], v[172:175], v[92:95], v[64:79]
    s_add_u32 s58, s56, 4096
    buffer_load_dwordx4 v[172:175], v127, s[20:23], s58 offen offset:3072 sc1
    v_mul_f32 v133, v133, v25
    v_mul_f32 v134, v134, v26
    v_mul_f32 v135, v135, v27
    v_exp_f32 v128, v128
    v_exp_f32 v129, v129
    ds_read_b128 v[92:95], v4 offset:37888
    s_waitcnt lgkmcnt(3)
    v_mfma_f32_32x32x16_bf16 v[48:63], v[176:179], v[80:83], v[48:63]
    v_exp_f32 v130, v130
    v_exp_f32 v131, v131
    v_exp_f32 v132, v132
    v_exp_f32 v133, v133
    v_exp_f32 v134, v134
    ds_read_b128 v[80:83], v4 offset:10240
    s_waitcnt lgkmcnt(3)
    v_mfma_f32_32x32x16_bf16 v[64:79], v[176:179], v[84:87], v[64:79]
    s_add_u32 s58, s56, 8192
    buffer_load_dwordx4 v[176:179], v127, s[20:23], s58 offen offset:0 sc1
    v_exp_f32 v135, v135
    v_add_f32 v128, 1.0, v128
    v_add_f32 v129, 1.0, v129
    v_add_f32 v130, 1.0, v130
    v_add_f32 v131, 1.0, v131
    ds_read_b128 v[84:87], v4 offset:38912
    s_waitcnt lgkmcnt(3)
    v_mfma_f32_32x32x16_bf16 v[48:63], v[180:183], v[88:91], v[48:63]
    v_add_f32 v132, 1.0, v132
    v_add_f32 v133, 1.0, v133
    v_add_f32 v134, 1.0, v134
    v_add_f32 v135, 1.0, v135
    v_rcp_f32 v128, v128
    ds_read_b128 v[88:91], v4 offset:11264
    s_waitcnt lgkmcnt(3)
    v_mfma_f32_32x32x16_bf16 v[64:79], v[180:183], v[92:95], v[64:79]
    s_add_u32 s58, s56, 8192
    buffer_load_dwordx4 v[180:183], v127, s[20:23], s58 offen offset:1024 sc1
    v_rcp_f32 v129, v129
    v_rcp_f32 v130, v130
    v_rcp_f32 v131, v131
    v_rcp_f32 v132, v132
    v_rcp_f32 v133, v133
    ds_read_b128 v[92:95], v4 offset:39936
    s_waitcnt lgkmcnt(3)
    v_mfma_f32_32x32x16_bf16 v[48:63], v[184:187], v[80:83], v[48:63]
    v_rcp_f32 v134, v134
    v_rcp_f32 v135, v135
    v_mul_f32 v16, v16, v128
    v_mul_f32 v17, v17, v129
    v_mul_f32 v18, v18, v130
    ds_read_b128 v[80:83], v4 offset:12288
    s_waitcnt lgkmcnt(3)
    v_mfma_f32_32x32x16_bf16 v[64:79], v[184:187], v[84:87], v[64:79]
    s_add_u32 s58, s56, 8192
    buffer_load_dwordx4 v[184:187], v127, s[20:23], s58 offen offset:2048 sc1
    v_mul_f32 v19, v19, v131
    v_mul_f32 v24, v24, v132
    v_mul_f32 v25, v25, v133
    v_mul_f32 v26, v26, v134
    v_mul_f32 v27, v27, v135
    ds_read_b128 v[84:87], v4 offset:40960
    s_waitcnt lgkmcnt(3)
    v_mfma_f32_32x32x16_bf16 v[48:63], v[188:191], v[88:91], v[48:63]
    v_cvt_pk_bf16_f32 v128, v16, v17
    v_lshlrev_b32 v16, 16, v128
    v_and_b32 v17, 0xffff0000, v128
    v_cvt_pk_bf16_f32 v130, v18, v19
    v_lshlrev_b32 v18, 16, v130
    ds_read_b128 v[88:91], v4 offset:13312
    s_waitcnt lgkmcnt(3)
    v_mfma_f32_32x32x16_bf16 v[64:79], v[188:191], v[92:95], v[64:79]
    s_add_u32 s58, s56, 8192
    buffer_load_dwordx4 v[188:191], v127, s[20:23], s58 offen offset:3072 sc1
    v_and_b32 v19, 0xffff0000, v130
    v_cvt_pk_bf16_f32 v132, v24, v25
    v_lshlrev_b32 v24, 16, v132
    v_and_b32 v25, 0xffff0000, v132
    v_cvt_pk_bf16_f32 v134, v26, v27
    ds_read_b128 v[92:95], v4 offset:41984
    s_waitcnt lgkmcnt(3)
    v_mfma_f32_32x32x16_bf16 v[48:63], v[192:195], v[80:83], v[48:63]
    v_lshlrev_b32 v26, 16, v134
    v_and_b32 v27, 0xffff0000, v134
    v_mul_f32 v16, v16, v20
    v_mul_f32 v17, v17, v21
    v_mul_f32 v18, v18, v22
    ds_read_b128 v[80:83], v4 offset:14336
    s_waitcnt lgkmcnt(3)
    v_mfma_f32_32x32x16_bf16 v[64:79], v[192:195], v[84:87], v[64:79]
    s_add_u32 s58, s56, 12288
    buffer_load_dwordx4 v[192:195], v127, s[20:23], s58 offen offset:0 sc1
    v_mul_f32 v19, v19, v23
    v_mul_f32 v24, v24, v28
    v_mul_f32 v25, v25, v29
    v_mul_f32 v26, v26, v30
    v_mul_f32 v27, v27, v31
    ds_read_b128 v[84:87], v4 offset:43008
    s_waitcnt lgkmcnt(3)
    v_mfma_f32_32x32x16_bf16 v[48:63], v[196:199], v[88:91], v[48:63]
    v_cvt_pk_bf16_f32 v8, v16, v17
    v_cvt_pk_bf16_f32 v9, v18, v19
    v_cvt_pk_bf16_f32 v10, v24, v25
    v_cvt_pk_bf16_f32 v11, v26, v27
    s_add_u32 s35, s34, 0
    ds_read_b128 v[88:91], v4 offset:15360
    s_waitcnt lgkmcnt(3)
    v_mfma_f32_32x32x16_bf16 v[64:79], v[196:199], v[92:95], v[64:79]
    s_add_u32 s58, s56, 12288
    buffer_load_dwordx4 v[196:199], v127, s[20:23], s58 offen offset:1024 sc1
    buffer_store_dwordx4 v[8:11], v127, s[20:23], s35 offen sc1
    v_cvt_pk_bf16_f32 v128, v32, v33
    v_lshlrev_b32 v32, 16, v128
    v_and_b32 v33, 0xffff0000, v128
    v_cvt_pk_bf16_f32 v129, v36, v37
    ds_read_b128 v[92:95], v4 offset:44032
    s_waitcnt lgkmcnt(3)
    v_mfma_f32_32x32x16_bf16 v[48:63], v[200:203], v[80:83], v[48:63]
    v_lshlrev_b32 v36, 16, v129
    v_and_b32 v37, 0xffff0000, v129
    v_cvt_pk_bf16_f32 v130, v34, v35
    v_lshlrev_b32 v34, 16, v130
    v_and_b32 v35, 0xffff0000, v130
    ds_read_b128 v[80:83], v4 offset:16384
    s_waitcnt lgkmcnt(3)
    v_mfma_f32_32x32x16_bf16 v[64:79], v[200:203], v[84:87], v[64:79]
    s_add_u32 s58, s56, 114688
    buffer_load_dwordx4 v[200:203], v127, s[20:23], s58 offen offset:0 sc1
    v_cvt_pk_bf16_f32 v131, v38, v39
    v_lshlrev_b32 v38, 16, v131
    v_and_b32 v39, 0xffff0000, v131
    v_cvt_pk_bf16_f32 v132, v40, v41
    v_lshlrev_b32 v40, 16, v132
    ds_read_b128 v[84:87], v4 offset:45056
    s_waitcnt lgkmcnt(3)
    v_mfma_f32_32x32x16_bf16 v[48:63], v[204:207], v[88:91], v[48:63]
    v_and_b32 v41, 0xffff0000, v132
    v_cvt_pk_bf16_f32 v133, v44, v45
    v_lshlrev_b32 v44, 16, v133
    v_and_b32 v45, 0xffff0000, v133
    v_cvt_pk_bf16_f32 v134, v42, v43
    ds_read_b128 v[88:91], v4 offset:17408
    s_waitcnt lgkmcnt(3)
    v_mfma_f32_32x32x16_bf16 v[64:79], v[204:207], v[92:95], v[64:79]
    s_add_u32 s58, s56, 114688
    buffer_load_dwordx4 v[204:207], v127, s[20:23], s58 offen offset:1024 sc1
    v_lshlrev_b32 v42, 16, v134
    v_and_b32 v43, 0xffff0000, v134
    v_cvt_pk_bf16_f32 v135, v46, v47
    v_lshlrev_b32 v46, 16, v135
    v_and_b32 v47, 0xffff0000, v135
    ds_read_b128 v[92:95], v4 offset:46080
    s_waitcnt lgkmcnt(3)
    v_mfma_f32_32x32x16_bf16 v[48:63], v[208:211], v[80:83], v[48:63]
    v_mul_f32 v128, v32, v32
    v_mul_f32 v129, v33, v33
    v_mul_f32 v130, v34, v34
    v_mul_f32 v131, v35, v35
    v_mul_f32 v132, v40, v40
    ds_read_b128 v[80:83], v4 offset:18432
    s_waitcnt lgkmcnt(3)
    v_mfma_f32_32x32x16_bf16 v[64:79], v[208:211], v[84:87], v[64:79]
    s_add_u32 s58, s56, 114688
    buffer_load_dwordx4 v[208:211], v127, s[20:23], s58 offen offset:2048 sc1
    v_mul_f32 v133, v41, v41
    v_mul_f32 v134, v42, v42
    v_mul_f32 v135, v43, v43
    v_fma_f32 v128, v128, v125, v124
    v_fma_f32 v129, v129, v125, v124
    ds_read_b128 v[84:87], v4 offset:47104
    s_waitcnt lgkmcnt(3)
    v_mfma_f32_32x32x16_bf16 v[48:63], v[212:215], v[88:91], v[48:63]
    v_fma_f32 v130, v130, v125, v124
    v_fma_f32 v131, v131, v125, v124
    v_fma_f32 v132, v132, v125, v124
    v_fma_f32 v133, v133, v125, v124
    v_fma_f32 v134, v134, v125, v124
    ds_read_b128 v[88:91], v4 offset:19456
    s_waitcnt lgkmcnt(3)
    v_mfma_f32_32x32x16_bf16 v[64:79], v[212:215], v[92:95], v[64:79]
    s_add_u32 s58, s56, 114688
    buffer_load_dwordx4 v[212:215], v127, s[20:23], s58 offen offset:3072 sc1
    v_fma_f32 v135, v135, v125, v124
    v_mul_f32 v128, v128, v32
    v_mul_f32 v129, v129, v33
    v_mul_f32 v130, v130, v34
    v_mul_f32 v131, v131, v35
    ds_read_b128 v[92:95], v4 offset:48128
    s_waitcnt lgkmcnt(3)
    v_mfma_f32_32x32x16_bf16 v[48:63], v[216:219], v[80:83], v[48:63]
    v_mul_f32 v132, v132, v40
    v_mul_f32 v133, v133, v41
    v_mul_f32 v134, v134, v42
    v_mul_f32 v135, v135, v43
    v_exp_f32 v128, v128
    ds_read_b128 v[80:83], v4 offset:20480
    s_waitcnt lgkmcnt(3)
    v_mfma_f32_32x32x16_bf16 v[64:79], v[216:219], v[84:87], v[64:79]
    s_add_u32 s58, s56, 118784
    buffer_load_dwordx4 v[216:219], v127, s[20:23], s58 offen offset:0 sc1
    v_exp_f32 v129, v129
    v_exp_f32 v130, v130
    v_exp_f32 v131, v131
    v_exp_f32 v132, v132
    v_exp_f32 v133, v133
    ds_read_b128 v[84:87], v4 offset:49152
    s_waitcnt lgkmcnt(3)
    v_mfma_f32_32x32x16_bf16 v[48:63], v[220:223], v[88:91], v[48:63]
    v_exp_f32 v134, v134
    v_exp_f32 v135, v135
    v_add_f32 v128, 1.0, v128
    v_add_f32 v129, 1.0, v129
    v_add_f32 v130, 1.0, v130
    ds_read_b128 v[88:91], v4 offset:21504
    s_waitcnt lgkmcnt(3)
    v_mfma_f32_32x32x16_bf16 v[64:79], v[220:223], v[92:95], v[64:79]
    s_add_u32 s58, s56, 118784
    buffer_load_dwordx4 v[220:223], v127, s[20:23], s58 offen offset:1024 sc1
    v_add_f32 v131, 1.0, v131
    v_add_f32 v132, 1.0, v132
    v_add_f32 v133, 1.0, v133
    v_add_f32 v134, 1.0, v134
    v_add_f32 v135, 1.0, v135
    ds_read_b128 v[92:95], v4 offset:50176
    s_waitcnt lgkmcnt(3)
    v_mfma_f32_32x32x16_bf16 v[48:63], v[224:227], v[80:83], v[48:63]
    v_rcp_f32 v128, v128
    v_rcp_f32 v129, v129
    v_rcp_f32 v130, v130
    v_rcp_f32 v131, v131
    v_rcp_f32 v132, v132
    ds_read_b128 v[80:83], v4 offset:22528
    s_waitcnt lgkmcnt(3)
    v_mfma_f32_32x32x16_bf16 v[64:79], v[224:227], v[84:87], v[64:79]
    s_add_u32 s58, s56, 118784
    buffer_load_dwordx4 v[224:227], v127, s[20:23], s58 offen offset:2048 sc1
    v_rcp_f32 v133, v133
    v_rcp_f32 v134, v134
    v_rcp_f32 v135, v135
    v_mul_f32 v32, v32, v128
    v_mul_f32 v33, v33, v129
    ds_read_b128 v[84:87], v4 offset:51200
    s_waitcnt lgkmcnt(3)
    v_mfma_f32_32x32x16_bf16 v[48:63], v[228:231], v[88:91], v[48:63]
    v_mul_f32 v34, v34, v130
    v_mul_f32 v35, v35, v131
    v_mul_f32 v40, v40, v132
    v_mul_f32 v41, v41, v133
    v_mul_f32 v42, v42, v134
    ds_read_b128 v[88:91], v4 offset:23552
    s_waitcnt lgkmcnt(3)
    v_mfma_f32_32x32x16_bf16 v[64:79], v[228:231], v[92:95], v[64:79]
    s_add_u32 s58, s56, 118784
    buffer_load_dwordx4 v[228:231], v127, s[20:23], s58 offen offset:3072 sc1
    v_mul_f32 v43, v43, v135
    v_cvt_pk_bf16_f32 v128, v32, v33
    v_lshlrev_b32 v32, 16, v128
    v_and_b32 v33, 0xffff0000, v128
    v_cvt_pk_bf16_f32 v130, v34, v35
    ds_read_b128 v[92:95], v4 offset:52224
    s_waitcnt lgkmcnt(3)
    v_mfma_f32_32x32x16_bf16 v[48:63], v[232:235], v[80:83], v[48:63]
    v_lshlrev_b32 v34, 16, v130
    v_and_b32 v35, 0xffff0000, v130
    v_cvt_pk_bf16_f32 v132, v40, v41
    v_lshlrev_b32 v40, 16, v132
    v_and_b32 v41, 0xffff0000, v132
    ds_read_b128 v[80:83], v4 offset:24576
    s_waitcnt lgkmcnt(3)
    v_mfma_f32_32x32x16_bf16 v[64:79], v[232:235], v[84:87], v[64:79]
    s_add_u32 s58, s56, 122880
    buffer_load_dwordx4 v[232:235], v127, s[20:23], s58 offen offset:0 sc1
    v_cvt_pk_bf16_f32 v134, v42, v43
    v_lshlrev_b32 v42, 16, v134
    v_and_b32 v43, 0xffff0000, v134
    v_mul_f32 v32, v32, v36
    v_mul_f32 v33, v33, v37
    ds_read_b128 v[84:87], v4 offset:53248
    s_waitcnt lgkmcnt(3)
    v_mfma_f32_32x32x16_bf16 v[48:63], v[236:239], v[88:91], v[48:63]
    v_mul_f32 v34, v34, v38
    v_mul_f32 v35, v35, v39
    v_mul_f32 v40, v40, v44
    v_mul_f32 v41, v41, v45
    v_mul_f32 v42, v42, v46
    ds_read_b128 v[88:91], v4 offset:25600
    s_waitcnt lgkmcnt(3)
    v_mfma_f32_32x32x16_bf16 v[64:79], v[236:239], v[92:95], v[64:79]
    s_add_u32 s58, s56, 122880
    buffer_load_dwordx4 v[236:239], v127, s[20:23], s58 offen offset:1024 sc1
    v_mul_f32 v43, v43, v47
    v_cvt_pk_bf16_f32 v12, v32, v33
    v_cvt_pk_bf16_f32 v13, v34, v35
    v_cvt_pk_bf16_f32 v14, v40, v41
    v_cvt_pk_bf16_f32 v15, v42, v43
    ds_read_b128 v[92:95], v4 offset:54272
    s_waitcnt lgkmcnt(3)
    v_mfma_f32_32x32x16_bf16 v[48:63], v[240:243], v[80:83], v[48:63]
    s_add_u32 s35, s34, 114688
    buffer_store_dwordx4 v[12:15], v127, s[20:23], s35 offen sc1
    ds_read_b128 v[80:83], v4 offset:26624
    s_waitcnt lgkmcnt(3)
    v_mfma_f32_32x32x16_bf16 v[64:79], v[240:243], v[84:87], v[64:79]
    s_add_u32 s58, s56, 122880
    buffer_load_dwordx4 v[240:243], v127, s[20:23], s58 offen offset:2048 sc1
    ds_read_b128 v[84:87], v4 offset:55296
    s_waitcnt lgkmcnt(3)
    v_mfma_f32_32x32x16_bf16 v[48:63], v[244:247], v[88:91], v[48:63]
    ds_read_b128 v[88:91], v4 offset:27648
    s_waitcnt lgkmcnt(3)
    v_mfma_f32_32x32x16_bf16 v[64:79], v[244:247], v[92:95], v[64:79]
    s_add_u32 s58, s56, 122880
    buffer_load_dwordx4 v[244:247], v127, s[20:23], s58 offen offset:3072 sc1
    ds_read_b128 v[92:95], v4 offset:56320
    s_waitcnt lgkmcnt(3)
    v_mfma_f32_32x32x16_bf16 v[48:63], v[248:251], v[80:83], v[48:63]
    s_waitcnt lgkmcnt(2)
    v_mfma_f32_32x32x16_bf16 v[64:79], v[248:251], v[84:87], v[64:79]
    s_add_u32 s58, s56, 126976
    buffer_load_dwordx4 v[248:251], v127, s[20:23], s58 offen offset:0 sc1
    s_waitcnt lgkmcnt(1)
    v_mfma_f32_32x32x16_bf16 v[48:63], v[252:255], v[88:91], v[48:63]
    s_waitcnt lgkmcnt(0)
    v_mfma_f32_32x32x16_bf16 v[64:79], v[252:255], v[92:95], v[64:79]
    s_add_u32 s58, s56, 126976
    buffer_load_dwordx4 v[252:255], v127, s[20:23], s58 offen offset:1024 sc1
    s_nop 11
    v_cvt_pk_bf16_f32 v128, v48, v49
    v_lshlrev_b32 v48, 16, v128
    v_and_b32 v49, 0xffff0000, v128
    v_cvt_pk_bf16_f32 v129, v52, v53
    v_lshlrev_b32 v52, 16, v129
    v_and_b32 v53, 0xffff0000, v129
    v_cvt_pk_bf16_f32 v130, v50, v51
    v_lshlrev_b32 v50, 16, v130
    v_and_b32 v51, 0xffff0000, v130
    v_cvt_pk_bf16_f32 v131, v54, v55
    v_lshlrev_b32 v54, 16, v131
    v_and_b32 v55, 0xffff0000, v131
    v_cvt_pk_bf16_f32 v132, v56, v57
    v_lshlrev_b32 v56, 16, v132
    v_and_b32 v57, 0xffff0000, v132
    v_cvt_pk_bf16_f32 v133, v60, v61
    v_lshlrev_b32 v60, 16, v133
    v_and_b32 v61, 0xffff0000, v133
    v_cvt_pk_bf16_f32 v134, v58, v59
    v_lshlrev_b32 v58, 16, v134
    v_and_b32 v59, 0xffff0000, v134
    v_cvt_pk_bf16_f32 v135, v62, v63
    v_lshlrev_b32 v62, 16, v135
    v_and_b32 v63, 0xffff0000, v135
    v_mul_f32 v128, v48, v48
    v_mul_f32 v129, v49, v49
    v_mul_f32 v130, v50, v50
    v_mul_f32 v131, v51, v51
    v_mul_f32 v132, v56, v56
    v_mul_f32 v133, v57, v57
    v_mul_f32 v134, v58, v58
    v_mul_f32 v135, v59, v59
    v_fma_f32 v128, v128, v125, v124
    v_fma_f32 v129, v129, v125, v124
    v_fma_f32 v130, v130, v125, v124
    v_fma_f32 v131, v131, v125, v124
    v_fma_f32 v132, v132, v125, v124
    v_fma_f32 v133, v133, v125, v124
    v_fma_f32 v134, v134, v125, v124
    v_fma_f32 v135, v135, v125, v124
    v_mul_f32 v128, v128, v48
    v_mul_f32 v129, v129, v49
    v_mul_f32 v130, v130, v50
    v_mul_f32 v131, v131, v51
    v_mul_f32 v132, v132, v56
    v_mul_f32 v133, v133, v57
    v_mul_f32 v134, v134, v58
    v_mul_f32 v135, v135, v59
    v_exp_f32 v128, v128
    v_exp_f32 v129, v129
    v_exp_f32 v130, v130
    v_exp_f32 v131, v131
    v_exp_f32 v132, v132
    v_exp_f32 v133, v133
    v_exp_f32 v134, v134
    v_exp_f32 v135, v135
    v_add_f32 v128, 1.0, v128
    v_add_f32 v129, 1.0, v129
    v_add_f32 v130, 1.0, v130
    v_add_f32 v131, 1.0, v131
    v_add_f32 v132, 1.0, v132
    v_add_f32 v133, 1.0, v133
    v_add_f32 v134, 1.0, v134
    v_add_f32 v135, 1.0, v135
    v_rcp_f32 v128, v128
    v_rcp_f32 v129, v129
    v_rcp_f32 v130, v130
    v_rcp_f32 v131, v131
    v_rcp_f32 v132, v132
    v_rcp_f32 v133, v133
    v_rcp_f32 v134, v134
    v_rcp_f32 v135, v135
    v_mul_f32 v48, v48, v128
    v_mul_f32 v49, v49, v129
    v_mul_f32 v50, v50, v130
    v_mul_f32 v51, v51, v131
    v_mul_f32 v56, v56, v132
    v_mul_f32 v57, v57, v133
    v_mul_f32 v58, v58, v134
    v_mul_f32 v59, v59, v135
    v_cvt_pk_bf16_f32 v128, v48, v49
    v_lshlrev_b32 v48, 16, v128
    v_and_b32 v49, 0xffff0000, v128
    v_cvt_pk_bf16_f32 v130, v50, v51
    v_lshlrev_b32 v50, 16, v130
    v_and_b32 v51, 0xffff0000, v130
    v_cvt_pk_bf16_f32 v132, v56, v57
    v_lshlrev_b32 v56, 16, v132
    v_and_b32 v57, 0xffff0000, v132
    v_cvt_pk_bf16_f32 v134, v58, v59
    v_lshlrev_b32 v58, 16, v134
    v_and_b32 v59, 0xffff0000, v134
    v_mul_f32 v48, v48, v52
    v_mul_f32 v49, v49, v53
    v_mul_f32 v50, v50, v54
    v_mul_f32 v51, v51, v55
    v_mul_f32 v56, v56, v60
    v_mul_f32 v57, v57, v61
    v_mul_f32 v58, v58, v62
    v_mul_f32 v59, v59, v63
    v_cvt_pk_bf16_f32 v8, v48, v49
    v_cvt_pk_bf16_f32 v9, v50, v51
    v_cvt_pk_bf16_f32 v10, v56, v57
    v_cvt_pk_bf16_f32 v11, v58, v59
    s_add_u32 s35, s34, 229376
    buffer_store_dwordx4 v[8:11], v127, s[20:23], s35 offen sc1
    v_cvt_pk_bf16_f32 v128, v64, v65
    v_lshlrev_b32 v64, 16, v128
    v_and_b32 v65, 0xffff0000, v128
    v_cvt_pk_bf16_f32 v129, v68, v69
    v_lshlrev_b32 v68, 16, v129
    v_and_b32 v69, 0xffff0000, v129
    v_cvt_pk_bf16_f32 v130, v66, v67
    v_lshlrev_b32 v66, 16, v130
    v_and_b32 v67, 0xffff0000, v130
    v_cvt_pk_bf16_f32 v131, v70, v71
    v_lshlrev_b32 v70, 16, v131
    v_and_b32 v71, 0xffff0000, v131
    v_cvt_pk_bf16_f32 v132, v72, v73
    v_lshlrev_b32 v72, 16, v132
    v_and_b32 v73, 0xffff0000, v132
    v_cvt_pk_bf16_f32 v133, v76, v77
    v_lshlrev_b32 v76, 16, v133
    v_and_b32 v77, 0xffff0000, v133
    v_cvt_pk_bf16_f32 v134, v74, v75
    v_lshlrev_b32 v74, 16, v134
    v_and_b32 v75, 0xffff0000, v134
    v_cvt_pk_bf16_f32 v135, v78, v79
    v_lshlrev_b32 v78, 16, v135
    v_and_b32 v79, 0xffff0000, v135
    v_mul_f32 v128, v64, v64
    v_mul_f32 v129, v65, v65
    v_mul_f32 v130, v66, v66
    v_mul_f32 v131, v67, v67
    v_mul_f32 v132, v72, v72
    v_mul_f32 v133, v73, v73
    v_mul_f32 v134, v74, v74
    v_mul_f32 v135, v75, v75
    v_fma_f32 v128, v128, v125, v124
    v_fma_f32 v129, v129, v125, v124
    v_fma_f32 v130, v130, v125, v124
    v_fma_f32 v131, v131, v125, v124
    v_fma_f32 v132, v132, v125, v124
    v_fma_f32 v133, v133, v125, v124
    v_fma_f32 v134, v134, v125, v124
    v_fma_f32 v135, v135, v125, v124
    v_mul_f32 v128, v128, v64
    v_mul_f32 v129, v129, v65
    v_mul_f32 v130, v130, v66
    v_mul_f32 v131, v131, v67
    v_mul_f32 v132, v132, v72
    v_mul_f32 v133, v133, v73
    v_mul_f32 v134, v134, v74
    v_mul_f32 v135, v135, v75
    v_exp_f32 v128, v128
    v_exp_f32 v129, v129
    v_exp_f32 v130, v130
    v_exp_f32 v131, v131
    v_exp_f32 v132, v132
    v_exp_f32 v133, v133
    v_exp_f32 v134, v134
    v_exp_f32 v135, v135
    v_add_f32 v128, 1.0, v128
    v_add_f32 v129, 1.0, v129
    v_add_f32 v130, 1.0, v130
    v_add_f32 v131, 1.0, v131
    v_add_f32 v132, 1.0, v132
    v_add_f32 v133, 1.0, v133
    v_add_f32 v134, 1.0, v134
    v_add_f32 v135, 1.0, v135
    v_rcp_f32 v128, v128
    v_rcp_f32 v129, v129
    v_rcp_f32 v130, v130
    v_rcp_f32 v131, v131
    v_rcp_f32 v132, v132
    v_rcp_f32 v133, v133
    v_rcp_f32 v134, v134
    v_rcp_f32 v135, v135
    v_mul_f32 v64, v64, v128
    v_mul_f32 v65, v65, v129
    v_mul_f32 v66, v66, v130
    v_mul_f32 v67, v67, v131
    v_mul_f32 v72, v72, v132
    v_mul_f32 v73, v73, v133
    v_mul_f32 v74, v74, v134
    v_mul_f32 v75, v75, v135
    v_cvt_pk_bf16_f32 v128, v64, v65
    v_lshlrev_b32 v64, 16, v128
    v_and_b32 v65, 0xffff0000, v128
    v_cvt_pk_bf16_f32 v130, v66, v67
    v_lshlrev_b32 v66, 16, v130
    v_and_b32 v67, 0xffff0000, v130
    v_cvt_pk_bf16_f32 v132, v72, v73
    v_lshlrev_b32 v72, 16, v132
    v_and_b32 v73, 0xffff0000, v132
    v_cvt_pk_bf16_f32 v134, v74, v75
    v_lshlrev_b32 v74, 16, v134
    v_and_b32 v75, 0xffff0000, v134
    v_mul_f32 v64, v64, v68
    v_mul_f32 v65, v65, v69
    v_mul_f32 v66, v66, v70
    v_mul_f32 v67, v67, v71
    v_mul_f32 v72, v72, v76
    v_mul_f32 v73, v73, v77
    v_mul_f32 v74, v74, v78
    v_mul_f32 v75, v75, v79
    v_cvt_pk_bf16_f32 v12, v64, v65
    v_cvt_pk_bf16_f32 v13, v66, v67
    v_cvt_pk_bf16_f32 v14, v72, v73
    v_cvt_pk_bf16_f32 v15, v74, v75
    s_add_u32 s35, s34, 344064
    buffer_store_dwordx4 v[12:15], v127, s[20:23], s35 offen sc1
    s_lshl_b32 s59, s50, 7
    s_add_u32 s58, s59, 0xc800
    s_add_u32 s59, s59, 0x9100
    s_waitcnt vmcnt(0)
    s_barrier
    s_cmp_lg_u32 s3, 0
    s_cbranch_scc1 ARR_16B
    v_mov_b32 v1, 0
    v_mov_b32 v2, 1
    s_mov_b64 exec, 1
    buffer_atomic_add v2, v1, s[20:23], s59 offen sc0 sc1
    s_barrier
    s_waitcnt vmcnt(0)
    v_cmp_eq_u32 vcc, 13, v2
    s_cbranch_vccz ARR_16X
    s_mov_b64 exec, 0x1
    v_lshlrev_b32 v1, 7, v0
    v_mov_b32 v2, 1
    buffer_store_dword v2, v1, s[20:23], s58 offen sc1
ARR_16X:
    s_mov_b64 exec, -1
    s_branch ARR_16E
ARR_16B:
    s_barrier
ARR_16E:
    s_lshr_b32 s59, s52, 1
    s_lshl_b32 s59, s59, 7
    s_add_u32 s59, s59, 0xc800
    s_cmp_lg_u32 s3, 7
    s_cbranch_scc1 WT_17
    v_and_b32 v1, 63, v0
    v_lshlrev_b32 v1, 2, v1
    s_mov_b64 exec, 0x1
    s_mov_b32 s60, 200000
    buffer_load_dword v4, v1, s[20:23], s59 offen sc1
    s_sleep 3
WT_17P:
    buffer_load_dword v5, v1, s[20:23], s59 offen sc1
    s_waitcnt vmcnt(1)
    v_cmp_eq_u32 vcc, 0, v4
    s_cbranch_vccz WT_17D
    s_sleep 3
    buffer_load_dword v4, v1, s[20:23], s59 offen sc1
    s_waitcnt vmcnt(1)
    v_cmp_eq_u32 vcc, 0, v5
    s_cbranch_vccz WT_17D
    s_sleep 3
    s_sub_u32 s60, s60, 1
    s_cmp_lg_u32 s60, 0
    s_cbranch_scc1 WT_17P
WT_17D:
    s_waitcnt vmcnt(0)
    s_mov_b64 exec, -1
WT_17:
    s_barrier
    v_mov_b32 v12, v127
    v_mov_b32 v13, v0
    s_mul_i32 s36, s52, 229376
    s_mul_i32 s57, s3, 14336
    s_add_u32 s36, s36, s57
    s_add_u32 s36, s36, 0x1000000
    s_load_dwordx2 s[6:7], s[0:1], 96
    v_lshrrev_b32 v4, 3, v0
    v_and_b32 v5, 7, v0
    s_lshl_b32 s38, s52, 6
    v_add_u32 v6, s38, v4
    s_movk_i32 s39, 896
    v_mul_lo_u32 v6, v6, s39
    v_lshl_add_u32 v6, v5, 4, v6
    s_lshl_b32 s38, s53, 7
    v_add_u32 v6, s38, v6
    v_lshl_add_u32 v7, v5, 4, s38
    s_mov_b32 s40, 0x400000
    buffer_load_dwordx4 v[8:11], v6, s[20:23], s40 offen sc1
    s_mov_b32 s42, 0x1180
    buffer_load_dwordx4 v[0:3], v7, s[20:23], s42 offen sc1
    s_add_u32 s58, s36, 0
    buffer_load_dwordx4 v[80:83], v12, s[20:23], s58 offen offset:0 sc1
    s_add_u32 s58, s36, 114688
    buffer_load_dwordx4 v[84:87], v12, s[20:23], s58 offen offset:0 sc1
    s_add_u32 s58, s36, 0
    buffer_load_dwordx4 v[88:91], v12, s[20:23], s58 offen offset:1024 sc1
    s_add_u32 s58, s36, 114688
    buffer_load_dwordx4 v[92:95], v12, s[20:23], s58 offen offset:1024 sc1
    s_add_u32 s58, s36, 0
    buffer_load_dwordx4 v[96:99], v12, s[20:23], s58 offen offset:2048 sc1
    s_add_u32 s58, s36, 114688
    buffer_load_dwordx4 v[100:103], v12, s[20:23], s58 offen offset:2048 sc1
    s_add_u32 s58, s36, 0
    buffer_load_dwordx4 v[104:107], v12, s[20:23], s58 offen offset:3072 sc1
    s_add_u32 s58, s36, 114688
    buffer_load_dwordx4 v[108:111], v12, s[20:23], s58 offen offset:3072 sc1
    s_add_u32 s58, s36, 4096
    buffer_load_dwordx4 v[112:115], v12, s[20:23], s58 offen offset:0 sc1
    s_add_u32 s58, s36, 118784
    buffer_load_dwordx4 v[116:119], v12, s[20:23], s58 offen offset:0 sc1
    s_add_u32 s58, s36, 4096
    buffer_load_dwordx4 v[120:123], v12, s[20:23], s58 offen offset:1024 sc1
    s_add_u32 s58, s36, 118784
    buffer_load_dwordx4 v[124:127], v12, s[20:23], s58 offen offset:1024 sc1
    s_add_u32 s58, s36, 4096
    buffer_load_dwordx4 v[128:131], v12, s[20:23], s58 offen offset:2048 sc1
    s_add_u32 s58, s36, 118784
    buffer_load_dwordx4 v[132:135], v12, s[20:23], s58 offen offset:2048 sc1
    s_add_u32 s58, s36, 4096
    buffer_load_dwordx4 v[136:139], v12, s[20:23], s58 offen offset:3072 sc1
    s_add_u32 s58, s36, 118784
    buffer_load_dwordx4 v[140:143], v12, s[20:23], s58 offen offset:3072 sc1
    s_waitcnt vmcnt(14)
    v_mfma_f32_32x32x16_bf16 v[16:31], v[144:147], v[80:83], 0
    v_mfma_f32_32x32x16_bf16 v[32:47], v[144:147], v[84:87], 0
    v_mfma_f32_32x32x16_bf16 v[48:63], v[200:203], v[80:83], 0
    v_mfma_f32_32x32x16_bf16 v[64:79], v[200:203], v[84:87], 0
    s_add_u32 s58, s36, 8192
    buffer_load_dwordx4 v[80:83], v12, s[20:23], s58 offen offset:0 sc1
    s_add_u32 s58, s36, 122880
    buffer_load_dwordx4 v[84:87], v12, s[20:23], s58 offen offset:0 sc1
    s_waitcnt vmcnt(14)
    v_mfma_f32_32x32x16_bf16 v[16:31], v[148:151], v[88:91], v[16:31]
    v_mfma_f32_32x32x16_bf16 v[32:47], v[148:151], v[92:95], v[32:47]
    v_mfma_f32_32x32x16_bf16 v[48:63], v[204:207], v[88:91], v[48:63]
    v_mfma_f32_32x32x16_bf16 v[64:79], v[204:207], v[92:95], v[64:79]
    s_add_u32 s58, s36, 8192
    buffer_load_dwordx4 v[88:91], v12, s[20:23], s58 offen offset:1024 sc1
    s_add_u32 s58, s36, 122880
    buffer_load_dwordx4 v[92:95], v12, s[20:23], s58 offen offset:1024 sc1
    s_waitcnt vmcnt(14)
    v_mfma_f32_32x32x16_bf16 v[16:31], v[152:155], v[96:99], v[16:31]
    v_mfma_f32_32x32x16_bf16 v[32:47], v[152:155], v[100:103], v[32:47]
    v_mfma_f32_32x32x16_bf16 v[48:63], v[208:211], v[96:99], v[48:63]
    v_mfma_f32_32x32x16_bf16 v[64:79], v[208:211], v[100:103], v[64:79]
    s_add_u32 s58, s36, 8192
    buffer_load_dwordx4 v[96:99], v12, s[20:23], s58 offen offset:2048 sc1
    s_add_u32 s58, s36, 122880
    buffer_load_dwordx4 v[100:103], v12, s[20:23], s58 offen offset:2048 sc1
    s_waitcnt vmcnt(14)
    v_mfma_f32_32x32x16_bf16 v[16:31], v[156:159], v[104:107], v[16:31]
    v_mfma_f32_32x32x16_bf16 v[32:47], v[156:159], v[108:111], v[32:47]
    v_mfma_f32_32x32x16_bf16 v[48:63], v[212:215], v[104:107], v[48:63]
    v_mfma_f32_32x32x16_bf16 v[64:79], v[212:215], v[108:111], v[64:79]
    s_add_u32 s58, s36, 8192
    buffer_load_dwordx4 v[104:107], v12, s[20:23], s58 offen offset:3072 sc1
    s_add_u32 s58, s36, 122880
    buffer_load_dwordx4 v[108:111], v12, s[20:23], s58 offen offset:3072 sc1
    s_waitcnt vmcnt(14)
    v_mfma_f32_32x32x16_bf16 v[16:31], v[160:163], v[112:115], v[16:31]
    v_mfma_f32_32x32x16_bf16 v[32:47], v[160:163], v[116:119], v[32:47]
    v_mfma_f32_32x32x16_bf16 v[48:63], v[216:219], v[112:115], v[48:63]
    v_mfma_f32_32x32x16_bf16 v[64:79], v[216:219], v[116:119], v[64:79]
    s_add_u32 s58, s36, 12288
    buffer_load_dwordx4 v[112:115], v12, s[20:23], s58 offen offset:0 sc1
    s_add_u32 s58, s36, 126976
    buffer_load_dwordx4 v[116:119], v12, s[20:23], s58 offen offset:0 sc1
    s_waitcnt vmcnt(14)
    v_mfma_f32_32x32x16_bf16 v[16:31], v[164:167], v[120:123], v[16:31]
    v_mfma_f32_32x32x16_bf16 v[32:47], v[164:167], v[124:127], v[32:47]
    v_mfma_f32_32x32x16_bf16 v[48:63], v[220:223], v[120:123], v[48:63]
    v_mfma_f32_32x32x16_bf16 v[64:79], v[220:223], v[124:127], v[64:79]
    s_add_u32 s58, s36, 12288
    buffer_load_dwordx4 v[120:123], v12, s[20:23], s58 offen offset:1024 sc1
    s_add_u32 s58, s36, 126976
    buffer_load_dwordx4 v[124:127], v12, s[20:23], s58 offen offset:1024 sc1
    s_waitcnt vmcnt(14)
    v_mfma_f32_32x32x16_bf16 v[16:31], v[168:171], v[128:131], v[16:31]
    v_mfma_f32_32x32x16_bf16 v[32:47], v[168:171], v[132:135], v[32:47]
    v_mfma_f32_32x32x16_bf16 v[48:63], v[224:227], v[128:131], v[48:63]
    v_mfma_f32_32x32x16_bf16 v[64:79], v[224:227], v[132:135], v[64:79]
    s_waitcnt vmcnt(12)
    v_mfma_f32_32x32x16_bf16 v[16:31], v[172:175], v[136:139], v[16:31]
    v_mfma_f32_32x32x16_bf16 v[32:47], v[172:175], v[140:143], v[32:47]
    v_mfma_f32_32x32x16_bf16 v[48:63], v[228:231], v[136:139], v[48:63]
    v_mfma_f32_32x32x16_bf16 v[64:79], v[228:231], v[140:143], v[64:79]
    s_waitcnt vmcnt(10)
    v_mfma_f32_32x32x16_bf16 v[16:31], v[176:179], v[80:83], v[16:31]
    v_mfma_f32_32x32x16_bf16 v[32:47], v[176:179], v[84:87], v[32:47]
    v_mfma_f32_32x32x16_bf16 v[48:63], v[232:235], v[80:83], v[48:63]
    v_mfma_f32_32x32x16_bf16 v[64:79], v[232:235], v[84:87], v[64:79]
    s_waitcnt vmcnt(8)
    v_mfma_f32_32x32x16_bf16 v[16:31], v[180:183], v[88:91], v[16:31]
    v_mfma_f32_32x32x16_bf16 v[32:47], v[180:183], v[92:95], v[32:47]
    v_mfma_f32_32x32x16_bf16 v[48:63], v[236:239], v[88:91], v[48:63]
    v_mfma_f32_32x32x16_bf16 v[64:79], v[236:239], v[92:95], v[64:79]
    s_waitcnt vmcnt(6)
    v_mfma_f32_32x32x16_bf16 v[16:31], v[184:187], v[96:99], v[16:31]
    v_mfma_f32_32x32x16_bf16 v[32:47], v[184:187], v[100:103], v[32:47]
    v_mfma_f32_32x32x16_bf16 v[48:63], v[240:243], v[96:99], v[48:63]
    v_mfma_f32_32x32x16_bf16 v[64:79], v[240:243], v[100:103], v[64:79]
    s_waitcnt vmcnt(4)
    v_mfma_f32_32x32x16_bf16 v[16:31], v[188:191], v[104:107], v[16:31]
    v_mfma_f32_32x32x16_bf16 v[32:47], v[188:191], v[108:111], v[32:47]
    v_mfma_f32_32x32x16_bf16 v[48:63], v[244:247], v[104:107], v[48:63]
    v_mfma_f32_32x32x16_bf16 v[64:79], v[244:247], v[108:111], v[64:79]
    s_waitcnt vmcnt(2)
    v_mfma_f32_32x32x16_bf16 v[16:31], v[192:195], v[112:115], v[16:31]
    v_mfma_f32_32x32x16_bf16 v[32:47], v[192:195], v[116:119], v[32:47]
    v_mfma_f32_32x32x16_bf16 v[48:63], v[248:251], v[112:115], v[48:63]
    v_mfma_f32_32x32x16_bf16 v[64:79], v[248:251], v[116:119], v[64:79]
    s_waitcnt vmcnt(0)
    v_mfma_f32_32x32x16_bf16 v[16:31], v[196:199], v[120:123], v[16:31]
    v_mfma_f32_32x32x16_bf16 v[32:47], v[196:199], v[124:127], v[32:47]
    v_mfma_f32_32x32x16_bf16 v[48:63], v[252:255], v[120:123], v[48:63]
    v_mfma_f32_32x32x16_bf16 v[64:79], v[252:255], v[124:127], v[64:79]
    v_mov_b32 v80, v8
    v_mov_b32 v88, v0
    v_mov_b32 v81, v9
    v_mov_b32 v89, v1
    v_mov_b32 v82, v10
    v_mov_b32 v90, v2
    v_mov_b32 v83, v11
    v_mov_b32 v91, v3
    v_mov_b32 v0, v13
    v_and_b32 v8, 31, v0
    v_bfe_u32 v9, v0, 5, 1
    v_mul_u32_u24 v8, 272, v8
    v_lshl_add_u32 v8, v9, 4, v8
    s_mul_i32 s38, s3, 17408
    v_add_u32 v8, s38, v8
    v_mul_u32_u24 v9, 272, v4
    v_lshl_add_u32 v9, v5, 5, v9
    v_add_u32 v10, 52224, v9
    v_add_u32 v11, 104448, v9
    s_waitcnt lgkmcnt(0)
    s_mov_b32 s8, s6
    s_and_b32 s9, s7, 0xffff
    s_mov_b32 s10, 0x1c0000
    s_mov_b32 s11, 0x00020000
    s_nop 1
    ds_write_b128 v8, v[16:19] offset:0
    ds_write_b128 v8, v[20:23] offset:32
    ds_write_b128 v8, v[24:27] offset:64
    ds_write_b128 v8, v[28:31] offset:96
    ds_write_b128 v8, v[32:35] offset:8704
    ds_write_b128 v8, v[36:39] offset:8736
    ds_write_b128 v8, v[40:43] offset:8768
    ds_write_b128 v8, v[44:47] offset:8800
    ds_write_b128 v8, v[48:51] offset:128
    ds_write_b128 v8, v[52:55] offset:160
    ds_write_b128 v8, v[56:59] offset:192
    ds_write_b128 v8, v[60:63] offset:224
    ds_write_b128 v8, v[64:67] offset:8832
    ds_write_b128 v8, v[68:71] offset:8864
    ds_write_b128 v8, v[72:75] offset:8896
    ds_write_b128 v8, v[76:79] offset:8928
    s_waitcnt lgkmcnt(0)
    s_barrier
    ds_read_b128 v[144:147], v9 offset:0
    ds_read_b128 v[148:151], v9 offset:16
    ds_read_b128 v[152:155], v9 offset:17408
    ds_read_b128 v[156:159], v9 offset:17424
    ds_read_b128 v[160:163], v9 offset:34816
    ds_read_b128 v[164:167], v9 offset:34832
    ds_read_b128 v[168:171], v10 offset:0
    ds_read_b128 v[172:175], v10 offset:16
    ds_read_b128 v[176:179], v10 offset:17408
    ds_read_b128 v[180:183], v10 offset:17424
    ds_read_b128 v[184:187], v10 offset:34816
    ds_read_b128 v[188:191], v10 offset:34832
    ds_read_b128 v[192:195], v11 offset:0
    ds_read_b128 v[196:199], v11 offset:16
    ds_read_b128 v[200:203], v11 offset:17408
    ds_read_b128 v[204:207], v11 offset:17424
    s_waitcnt vmcnt(0)
    v_lshlrev_b32 v16, 16, v88
    v_and_b32 v17, 0xffff0000, v88
    v_lshlrev_b32 v24, 16, v80
    v_and_b32 v25, 0xffff0000, v80
    v_lshlrev_b32 v18, 16, v89
    v_and_b32 v19, 0xffff0000, v89
    v_lshlrev_b32 v26, 16, v81
    v_and_b32 v27, 0xffff0000, v81
    v_lshlrev_b32 v20, 16, v90
    v_and_b32 v21, 0xffff0000, v90
    v_lshlrev_b32 v28, 16, v82
    v_and_b32 v29, 0xffff0000, v82
    v_lshlrev_b32 v22, 16, v91
    v_and_b32 v23, 0xffff0000, v91
    v_lshlrev_b32 v30, 16, v83
    v_and_b32 v31, 0xffff0000, v83
    s_waitcnt lgkmcnt(0)
    v_add_f32 v144, v144, v176
    v_add_f32 v145, v145, v177
    v_add_f32 v146, v146, v178
    v_add_f32 v147, v147, v179
    v_add_f32 v148, v148, v180
    v_add_f32 v149, v149, v181
    v_add_f32 v150, v150, v182
    v_add_f32 v151, v151, v183
    v_add_f32 v152, v152, v184
    v_add_f32 v153, v153, v185
    v_add_f32 v154, v154, v186
    v_add_f32 v155, v155, v187
    v_add_f32 v156, v156, v188
    v_add_f32 v157, v157, v189
    v_add_f32 v158, v158, v190
    v_add_f32 v159, v159, v191
    v_add_f32 v160, v160, v192
    v_add_f32 v161, v161, v193
    v_add_f32 v162, v162, v194
    v_add_f32 v163, v163, v195
    v_add_f32 v164, v164, v196
    v_add_f32 v165, v165, v197
    v_add_f32 v166, v166, v198
    v_add_f32 v167, v167, v199
    v_add_f32 v168, v168, v200
    v_add_f32 v169, v169, v201
    v_add_f32 v170, v170, v202
    v_add_f32 v171, v171, v203
    v_add_f32 v172, v172, v204
    v_add_f32 v173, v173, v205
    v_add_f32 v174, v174, v206
    v_add_f32 v175, v175, v207
    v_add_f32 v144, v144, v160
    v_add_f32 v145, v145, v161
    v_add_f32 v146, v146, v162
    v_add_f32 v147, v147, v163
    v_add_f32 v148, v148, v164
    v_add_f32 v149, v149, v165
    v_add_f32 v150, v150, v166
    v_add_f32 v151, v151, v167
    v_add_f32 v152, v152, v168
    v_add_f32 v153, v153, v169
    v_add_f32 v154, v154, v170
    v_add_f32 v155, v155, v171
    v_add_f32 v156, v156, v172
    v_add_f32 v157, v157, v173
    v_add_f32 v158, v158, v174
    v_add_f32 v159, v159, v175
    v_add_f32 v144, v144, v152
    v_add_f32 v145, v145, v153
    v_add_f32 v146, v146, v154
    v_add_f32 v147, v147, v155
    v_add_f32 v148, v148, v156
    v_add_f32 v149, v149, v157
    v_add_f32 v150, v150, v158
    v_add_f32 v151, v151, v159
    v_cvt_pk_bf16_f32 v40, v144, v145
    v_lshlrev_b32 v144, 16, v40
    v_and_b32 v145, 0xffff0000, v40
    v_cvt_pk_bf16_f32 v42, v146, v147
    v_lshlrev_b32 v146, 16, v42
    v_and_b32 v147, 0xffff0000, v42
    v_cvt_pk_bf16_f32 v44, v148, v149
    v_lshlrev_b32 v148, 16, v44
    v_and_b32 v149, 0xffff0000, v44
    v_cvt_pk_bf16_f32 v46, v150, v151
    v_lshlrev_b32 v150, 16, v46
    v_and_b32 v151, 0xffff0000, v46
    v_mul_f32 v144, v144, v16
    v_mul_f32 v145, v145, v17
    v_mul_f32 v146, v146, v18
    v_mul_f32 v147, v147, v19
    v_mul_f32 v148, v148, v20
    v_mul_f32 v149, v149, v21
    v_mul_f32 v150, v150, v22
    v_mul_f32 v151, v151, v23
    v_cvt_pk_bf16_f32 v40, v144, v145
    v_lshlrev_b32 v144, 16, v40
    v_and_b32 v145, 0xffff0000, v40
    v_cvt_pk_bf16_f32 v42, v146, v147
    v_lshlrev_b32 v146, 16, v42
    v_and_b32 v147, 0xffff0000, v42
    v_cvt_pk_bf16_f32 v44, v148, v149
    v_lshlrev_b32 v148, 16, v44
    v_and_b32 v149, 0xffff0000, v44
    v_cvt_pk_bf16_f32 v46, v150, v151
    v_lshlrev_b32 v150, 16, v46
    v_and_b32 v151, 0xffff0000, v46
    v_add_f32 v144, v144, v24
    v_add_f32 v145, v145, v25
    v_add_f32 v146, v146, v26
    v_add_f32 v147, v147, v27
    v_add_f32 v148, v148, v28
    v_add_f32 v149, v149, v29
    v_add_f32 v150, v150, v30
    v_add_f32 v151, v151, v31
    v_cvt_pk_bf16_f32 v48, v144, v145
    v_cvt_pk_bf16_f32 v49, v146, v147
    v_cvt_pk_bf16_f32 v50, v148, v149
    v_cvt_pk_bf16_f32 v51, v150, v151
    buffer_store_dwordx4 v[48:51], v6, s[8:11], 0 offen
M_END:
    s_endpgm
M_CODE_END:
.section .rodata,"a"
.p2align 6
.amdhsa_kernel adaLN_cond__ssm_conv_h3__geglu_ffn__prompt_kernel
  .amdhsa_next_free_vgpr 256
  .amdhsa_next_free_sgpr 102
  .amdhsa_accum_offset 256
  .amdhsa_group_segment_fixed_size 0
  .amdhsa_kernarg_size 120
  .amdhsa_user_sgpr_count 2
  .amdhsa_user_sgpr_kernarg_segment_ptr 1
  .amdhsa_system_sgpr_workgroup_id_x 1
.end_amdhsa_kernel
```
